```python
import torch

def _softmax(x, axis=-1):
    return torch.softmax(x, dim=axis)
def _gelu(x):
    return torch.nn.functional.gelu(x, approximate="tanh")
def _silu(x):
    return torch.nn.functional.silu(x)
def _sigmoid(x):
    return torch.sigmoid(x)
def _layernorm(x, axis=-1, eps=1e-5):
    m = x.mean(dim=axis, keepdim=True)
    v = x.var(dim=axis, keepdim=True, unbiased=False)
    return (x - m) / torch.sqrt(v + eps)
def _scatter_add(tgt, idx, src, axis=0):
    return tgt.clone().index_add_(axis, idx, src)
def _segment_sum(src, seg, n):
    out = torch.zeros((n,) + src.shape[1:], dtype=src.dtype)
    return out.index_add_(0, seg, src)
def _pad(x, pw):
    flat = tuple(v for pair in reversed(pw) for v in pair)
    return torch.nn.functional.pad(x, flat)

kernel_name = 'gated_mix__spectral_fnet__softmax_full_mha__prompt'

def setup_inputs():

    _w = (lambda a: (lambda t: t.to(torch.bfloat16) if t.is_floating_point() else t)(torch.as_tensor(a)))
    def _A_setup():
        B, S, D = 1, 2048, 640
        ns = torch.arange(S)[:, None] * torch.arange(S)[None, :]
        nd = torch.arange(D)[:, None] * torch.arange(D)[None, :]
        Ws_re = torch.cos(-2.0 * torch.pi * ns / S).to(float)
        Ws_im = torch.sin(-2.0 * torch.pi * ns / S).to(float)
        Wd_re = torch.cos(-2.0 * torch.pi * nd / D).to(float)
        Wd_im = torch.sin(-2.0 * torch.pi * nd / D).to(float)
        return {
            "x": _w((lambda *s: torch.randn(*s, dtype=torch.bfloat16) * 0.05)(B, S, D)),
            "dft_seq_re": _w(Ws_re),
            "dft_seq_im": _w(Ws_im),
            "dft_hid_re": _w(Wd_re),
            "dft_hid_im": _w(Wd_im),
        }
    _A_in = _A_setup()

    def _B_setup():
        B, S, D = 1, 2048, 640
        return {
            "x": _w((lambda *s: torch.randn(*s, dtype=torch.bfloat16) * 0.05)(B, S, D)),
            "wqkv": _w((lambda *s: torch.randn(*s, dtype=torch.bfloat16) * 1.6)(D, 3 * D)),
            "wo": _w((lambda *s: torch.randn(*s, dtype=torch.bfloat16) * 1.6)(D, D)),
        }
    _B_in = _B_setup()

    return {
        "A_x": _A_in["x"],
        "A_dft_seq_re": _A_in["dft_seq_re"],
        "A_dft_seq_im": _A_in["dft_seq_im"],
        "A_dft_hid_re": _A_in["dft_hid_re"],
        "A_dft_hid_im": _A_in["dft_hid_im"],
        "B_x": _B_in["x"],
        "B_wqkv": _B_in["wqkv"],
        "B_wo": _B_in["wo"],
        "gate_w": _w((lambda *s: torch.randn(*s, dtype=torch.bfloat16) * 0.05)(640) * 16.0),
    }

def reference(A_x, A_dft_seq_re, A_dft_seq_im, A_dft_hid_re, A_dft_hid_im, B_x, B_wqkv, B_wo, gate_w):
    def _A_ref(x, dft_seq_re, dft_seq_im, dft_hid_re, dft_hid_im):
        a = torch.einsum("bsd,ed->bse", x, dft_hid_re)
        b = torch.einsum("bsd,ed->bse", x, dft_hid_im)
        y = torch.einsum("ts,bse->bte", dft_seq_re, a) - torch.einsum("ts,bse->bte", dft_seq_im, b)
        return y

    def _B_ref(x, wqkv, wo):
        B, S, D = x.shape
        H = 32; Dh = D // H
        qkv = (lambda x, *d: x.permute(*d))((x @ wqkv).reshape(B, S, 3, H, Dh), 2, 0, 3, 1, 4)
        q, k, v = qkv[0], qkv[1], qkv[2]
        scale = Dh ** -0.5
        scores = torch.einsum("bhqd,bhkd->bhqk", q, k) * scale
        p = _softmax(scores, axis=-1)
        o = torch.einsum("bhqk,bhkd->bhqd", p, v)
        return (lambda x, *d: x.permute(*d))(o, 0, 2, 1, 3).reshape(B, S, D) @ wo

    x = A_x
    g = _sigmoid((x * gate_w).sum(-1, keepdims=True))
    a = _A_ref(x, A_dft_seq_re, A_dft_seq_im, A_dft_hid_re, A_dft_hid_im)
    b = _B_ref(x, B_wqkv, B_wo)
    return g * a + (1 - g) * b
```

```asm
; @launch grid=(256,1,1) block=(512,1,1) lds=155712
.amdgcn_target "amdgcn-amd-amdhsa--gfx950"
.text
.globl gated_mix__spectral_fnet__softmax_full_mha__prompt_kernel
.p2align 8
.type gated_mix__spectral_fnet__softmax_full_mha__prompt_kernel,@function
gated_mix__spectral_fnet__softmax_full_mha__prompt_kernel:
    s_cmp_ge_u32 s2, 256
    s_cbranch_scc1 L_end
    s_load_dwordx16 s[4:19], s[0:1], 0
    s_load_dwordx8 s[20:27], s[0:1], 64
    v_lshrrev_b32 v2, 6, v0
    v_and_b32 v1, 63, v0
    v_readfirstlane_b32 s52, v2
    s_and_b32 s53, s2, 7
    s_lshr_b32 s54, s2, 3
    s_xor_b32 s52, s52, 4
    s_and_b32 s98, s2, 3
    s_lshl_b32 s98, s98, 2
    s_and_b32 s56, s54, 3
    s_add_u32 s98, s98, s56
    s_lshr_b32 s56, s53, 2
    s_lshr_b32 s99, s54, 2
    s_cmp_eq_u32 s99, 7
    s_cselect_b32 s57, 1, 3
    s_lshl_b32 s56, s56, s57
    s_cmp_eq_u32 s99, 7
    s_cselect_b32 s57, s56, 0
    s_cselect_b32 s56, 0, s56
    s_add_u32 s98, s98, s57
    s_add_u32 s99, s99, s56
    s_mov_b32 s56, 0x210ba765
    s_mov_b32 s57, 0x43edc98
    s_lshl_b32 s99, s99, 2
    s_lshr_b64 s[56:57], s[56:57], s99
    s_and_b32 s99, s56, 15
    s_and_b32 s3, s52, 3
    s_and_b32 s100, s52, 1
    s_lshr_b32 s101, s3, 1
    s_cmp_lt_u32 s52, 4
    s_cbranch_scc1 L_comp
    s_setprio 3
    v_and_b32 v5, 7, v1
    v_lshrrev_b32 v6, 4, v1
    v_xor_b32 v5, v5, v6
    v_lshlrev_b32 v5, 4, v5
    v_xor_b32 v6, 64, v5
    v_bfe_u32 v7, v1, 3, 2
    v_lshrrev_b32 v3, 5, v1
    v_lshl_add_u32 v7, v3, 3, v7
    s_lshl_b32 s56, s98, 1
    s_add_u32 s56, s56, s101
    s_lshl_b32 s57, s100, 5
    s_add_u32 s58, s56, s57
    v_lshl_add_u32 v3, v7, 6, s58
    v_mul_u32_u24 v3, 1280, v3
    v_add_u32 v228, v3, v5
    v_add_u32 v229, v3, v6
    v_add_u32 v229, 326656, v229
    v_add_u32 v230, 1308672, v228
    v_add_u32 v231, 1308672, v229
    v_lshrrev_b32 v2, 4, v1
    v_bfe_u32 v3, v1, 2, 2
    v_xor_b32 v3, v3, v2
    v_and_b32 v4, 3, v1
    v_lshl_add_u32 v3, v3, 2, v4
    v_lshlrev_b32 v3, 4, v3
    s_lshl_b32 s56, s3, 4
    v_add_u32 v2, s56, v2
    v_mul_u32_u24 v2, 3840, v2
    s_lshl_b32 s56, s99, 8
    v_add3_u32 v232, v2, v3, s56
    v_add_u32 v233, 14336, v232
    v_add_u32 v234, 28672, v232
    v_add_u32 v235, 43008, v232
    s_lshl_b32 s56, s53, 2
    s_lshr_b32 s40, 0x20757520, s56
    s_and_b32 s40, s40, 15
    s_and_b32 s56, s54, 3
    s_mul_i32 s56, s56, 5
    s_add_u32 s40, s40, s56
    s_lshr_b32 s56, s54, 2
    s_mul_i32 s56, s56, 5
    s_add_u32 s40, s40, s56
    s_mul_i32 s56, s40, 205
    s_lshr_b32 s56, s56, 11
    s_mul_i32 s56, s56, 10
    s_sub_u32 s40, s40, s56
    s_mul_i32 s41, s40, 245760
    s_lshl_b32 s40, s40, 7
    s_lshl_b32 s42, s3, 12
    s_waitcnt lgkmcnt(0)
    s_load_dword s55, s[26:27], 0
    s_mov_b32 s28, s4
    s_and_b32 s29, s5, 0xffff
    s_mov_b32 s30, 0x280000
    s_mov_b32 s31, 0x20000
    s_cmp_ge_u32 s54, 30
    s_cbranch_scc1 L_lgate
    s_mov_b32 s32, s16
    s_and_b32 s33, s17, 0xffff
    s_mov_b32 s34, 0x258000
    s_mov_b32 s35, 0x20000
    s_add_u32 m0, s42, 0
    s_nop 0
    buffer_load_dwordx4 v228, s[28:31], s40 offen offset:0 lds
    buffer_load_dwordx4 v229, s[28:31], s40 offen offset:1024 lds
    buffer_load_dwordx4 v230, s[28:31], s40 offen offset:2048 lds
    buffer_load_dwordx4 v231, s[28:31], s40 offen offset:3072 lds
    s_add_u32 m0, s42, 16384
    s_add_u32 s40, s40, 128
    buffer_load_dwordx4 v232, s[32:35], s41 offen offset:0 lds
    buffer_load_dwordx4 v233, s[32:35], s41 offen offset:1024 lds
    buffer_load_dwordx4 v234, s[32:35], s41 offen offset:2048 lds
    buffer_load_dwordx4 v235, s[32:35], s41 offen offset:3072 lds
    s_add_u32 s41, s41, 245760
    s_cmp_eq_u32 s40, 1280
    s_cselect_b32 s40, 0, s40
    s_cselect_b32 s41, 0, s41
    s_add_u32 m0, s42, 32768
    s_nop 0
    buffer_load_dwordx4 v228, s[28:31], s40 offen offset:0 lds
    buffer_load_dwordx4 v229, s[28:31], s40 offen offset:1024 lds
    buffer_load_dwordx4 v230, s[28:31], s40 offen offset:2048 lds
    buffer_load_dwordx4 v231, s[28:31], s40 offen offset:3072 lds
    s_add_u32 m0, s42, 49152
    s_add_u32 s40, s40, 128
    buffer_load_dwordx4 v232, s[32:35], s41 offen offset:0 lds
    buffer_load_dwordx4 v233, s[32:35], s41 offen offset:1024 lds
    buffer_load_dwordx4 v234, s[32:35], s41 offen offset:2048 lds
    buffer_load_dwordx4 v235, s[32:35], s41 offen offset:3072 lds
    s_add_u32 s41, s41, 245760
    s_cmp_eq_u32 s40, 1280
    s_cselect_b32 s40, 0, s40
    s_cselect_b32 s41, 0, s41
    v_mov_b32 v9, 0
    v_mov_b32 v220, 0
    v_mov_b32 v221, 0
    v_mov_b32 v222, 0
    v_mov_b32 v223, 0
    s_mov_b32 s25, 0
    s_mov_b32 s24, 0
    s_mov_b32 s15, 0
    s_mov_b32 s44, s26
    s_and_b32 s45, s27, 0xffff
    s_mov_b32 s46, 0x49000
    s_mov_b32 s47, 0x20000
    v_mov_b32 v8, 155648
    s_mov_b32 s60, -1
    s_mov_b32 s61, 0
    s_mov_b32 s94, 0
    s_mov_b32 s95, -1
    s_mov_b32 s62, 0xfffff
    s_mov_b32 s63, 0xfffff
    s_mov_b32 s96, -1
    s_mov_b32 s97, 0xff
    s_lshr_b32 s43, s53, 2
    s_mul_i32 s43, s43, 5
    s_lshr_b32 s56, s54, 2
    s_add_u32 s43, s43, s56
    s_lshl_b32 s56, s43, 1
    s_add_u32 s56, s56, s100
    s_lshl_b32 s56, s56, 4
    v_add_u32 v7, s56, v7
    v_mul_u32_u24 v7, 1280, v7
    v_add_u32 v14, v7, v5
    v_add_u32 v15, v7, v6
    v_add_u32 v15, 4096, v15
    v_add_u32 v16, 409600, v5
    v_and_b32 v2, 31, v1
    v_lshrrev_b32 v3, 5, v1
    v_lshlrev_b32 v9, 5, v2
    v_lshl_add_u32 v9, v3, 4, v9
    s_mul_i32 s56, s58, 21504
    s_lshl_b32 s57, s43, 11
    s_add_u32 s56, s56, s57
    v_add_u32 v9, s56, v9
    s_mul_i32 s58, s58, 48
    s_lshl_b32 s57, s43, 2
    s_add_u32 s58, s58, s57
    s_add_u32 s58, s58, 1024
    v_and_b32 v2, 31, v1
    v_lshrrev_b32 v3, 5, v1
    v_bfe_u32 v4, v1, 1, 3
    v_xor_b32 v3, v3, v4
    v_lshlrev_b32 v3, 4, v3
    v_lshl_add_u32 v2, v2, 7, v3
    s_lshl_b32 s56, s3, 12
    v_add_u32 v10, s56, v2
    v_xor_b32 v11, 32, v10
    v_xor_b32 v12, 64, v10
    v_xor_b32 v13, 96, v10
    s_sub_u32 s56, s99, 1
    s_cmp_lt_u32 s56, 4
    s_cselect_b64 vcc, -1, 0
    s_waitcnt vmcnt(8) lgkmcnt(0)
    s_barrier
    s_cbranch_vccnz L_nx0
    ds_read_b128 v[20:23], v10 offset:0
    ds_read_b128 v[24:27], v11 offset:0
    ds_read_b128 v[28:31], v12 offset:0
    ds_read_b128 v[32:35], v13 offset:0
L_nx0:
    s_add_u32 m0, s42, 98304
    s_nop 0
    buffer_load_dwordx4 v228, s[28:31], s40 offen offset:0 lds
    buffer_load_dwordx4 v229, s[28:31], s40 offen offset:1024 lds
    buffer_load_dwordx4 v230, s[28:31], s40 offen offset:2048 lds
    buffer_load_dwordx4 v231, s[28:31], s40 offen offset:3072 lds
    s_add_u32 m0, s42, 114688
    s_add_u32 s40, s40, 128
    buffer_load_dwordx4 v232, s[32:35], s41 offen offset:0 lds
    buffer_load_dwordx4 v233, s[32:35], s41 offen offset:1024 lds
    buffer_load_dwordx4 v234, s[32:35], s41 offen offset:2048 lds
    buffer_load_dwordx4 v235, s[32:35], s41 offen offset:3072 lds
    s_add_u32 s41, s41, 245760
    s_cmp_eq_u32 s40, 1280
    s_cselect_b32 s40, 0, s40
    s_cselect_b32 s41, 0, s41
    s_waitcnt vmcnt(8) lgkmcnt(0)
    s_barrier
    s_cbranch_vccnz L_nx1
    ds_read_b128 v[36:39], v10 offset:32768
    ds_read_b128 v[40:43], v11 offset:32768
    ds_read_b128 v[44:47], v12 offset:32768
    ds_read_b128 v[48:51], v13 offset:32768
L_nx1:
    s_add_u32 m0, s42, 65536
    s_nop 0
    buffer_load_dwordx4 v228, s[28:31], s40 offen offset:0 lds
    buffer_load_dwordx4 v229, s[28:31], s40 offen offset:1024 lds
    buffer_load_dwordx4 v230, s[28:31], s40 offen offset:2048 lds
    buffer_load_dwordx4 v231, s[28:31], s40 offen offset:3072 lds
    s_add_u32 m0, s42, 81920
    s_add_u32 s40, s40, 128
    buffer_load_dwordx4 v232, s[32:35], s41 offen offset:0 lds
    buffer_load_dwordx4 v233, s[32:35], s41 offen offset:1024 lds
    buffer_load_dwordx4 v234, s[32:35], s41 offen offset:2048 lds
    buffer_load_dwordx4 v235, s[32:35], s41 offen offset:3072 lds
    s_add_u32 s41, s41, 245760
    s_cmp_eq_u32 s40, 1280
    s_cselect_b32 s40, 0, s40
    s_cselect_b32 s41, 0, s41
    v_xor_b32 v10, 0x10000, v10
    v_xor_b32 v11, 0x10000, v11
    v_xor_b32 v12, 0x10000, v12
    v_xor_b32 v13, 0x10000, v13
    s_waitcnt vmcnt(8) lgkmcnt(0)
    s_barrier
    s_cbranch_vccnz L_nx2
    ds_read_b128 v[52:55], v10 offset:32768
    ds_read_b128 v[56:59], v11 offset:32768
    ds_read_b128 v[60:63], v12 offset:32768
    ds_read_b128 v[64:67], v13 offset:32768
L_nx2:
    s_add_u32 m0, s42, 0
    s_nop 0
    buffer_load_dwordx4 v228, s[28:31], s40 offen offset:0 lds
    buffer_load_dwordx4 v229, s[28:31], s40 offen offset:1024 lds
    buffer_load_dwordx4 v230, s[28:31], s40 offen offset:2048 lds
    buffer_load_dwordx4 v231, s[28:31], s40 offen offset:3072 lds
    s_add_u32 m0, s42, 16384
    s_add_u32 s40, s40, 128
    buffer_load_dwordx4 v232, s[32:35], s41 offen offset:0 lds
    buffer_load_dwordx4 v233, s[32:35], s41 offen offset:1024 lds
    buffer_load_dwordx4 v234, s[32:35], s41 offen offset:2048 lds
    buffer_load_dwordx4 v235, s[32:35], s41 offen offset:3072 lds
    s_add_u32 s41, s41, 245760
    s_cmp_eq_u32 s40, 1280
    s_cselect_b32 s40, 0, s40
    s_cselect_b32 s41, 0, s41
    s_waitcnt vmcnt(8) lgkmcnt(0)
    s_barrier
    s_cbranch_vccnz L_nx3
    ds_read_b128 v[68:71], v10 offset:0
    ds_read_b128 v[72:75], v11 offset:0
    ds_read_b128 v[76:79], v12 offset:0
    ds_read_b128 v[80:83], v13 offset:0
L_nx3:
    s_add_u32 m0, s42, 32768
    s_nop 0
    buffer_load_dwordx4 v228, s[28:31], s40 offen offset:0 lds
    buffer_load_dwordx4 v229, s[28:31], s40 offen offset:1024 lds
    buffer_load_dwordx4 v230, s[28:31], s40 offen offset:2048 lds
    buffer_load_dwordx4 v231, s[28:31], s40 offen offset:3072 lds
    s_add_u32 m0, s42, 49152
    s_add_u32 s40, s40, 128
    buffer_load_dwordx4 v232, s[32:35], s41 offen offset:0 lds
    buffer_load_dwordx4 v233, s[32:35], s41 offen offset:1024 lds
    buffer_load_dwordx4 v234, s[32:35], s41 offen offset:2048 lds
    buffer_load_dwordx4 v235, s[32:35], s41 offen offset:3072 lds
    s_add_u32 s41, s41, 245760
    s_cmp_eq_u32 s40, 1280
    s_cselect_b32 s40, 0, s40
    s_cselect_b32 s41, 0, s41
    v_xor_b32 v10, 0x10000, v10
    v_xor_b32 v11, 0x10000, v11
    v_xor_b32 v12, 0x10000, v12
    v_xor_b32 v13, 0x10000, v13
    s_waitcnt vmcnt(8) lgkmcnt(0)
    s_barrier
    s_cbranch_vccnz L_nx4
    ds_read_b128 v[84:87], v10 offset:0
    ds_read_b128 v[88:91], v11 offset:0
    ds_read_b128 v[92:95], v12 offset:0
    ds_read_b128 v[96:99], v13 offset:0
L_nx4:
    s_add_u32 m0, s42, 98304
    s_nop 0
    buffer_load_dwordx4 v228, s[28:31], s40 offen offset:0 lds
    buffer_load_dwordx4 v229, s[28:31], s40 offen offset:1024 lds
    buffer_load_dwordx4 v230, s[28:31], s40 offen offset:2048 lds
    buffer_load_dwordx4 v231, s[28:31], s40 offen offset:3072 lds
    s_add_u32 m0, s42, 114688
    s_add_u32 s40, s40, 128
    buffer_load_dwordx4 v232, s[32:35], s41 offen offset:0 lds
    buffer_load_dwordx4 v233, s[32:35], s41 offen offset:1024 lds
    buffer_load_dwordx4 v234, s[32:35], s41 offen offset:2048 lds
    buffer_load_dwordx4 v235, s[32:35], s41 offen offset:3072 lds
    s_add_u32 s41, s41, 245760
    s_cmp_eq_u32 s40, 1280
    s_cselect_b32 s40, 0, s40
    s_cselect_b32 s41, 0, s41
    s_waitcnt vmcnt(8) lgkmcnt(0)
    s_barrier
    s_cbranch_vccnz L_nx5
    ds_read_b128 v[100:103], v10 offset:32768
    ds_read_b128 v[104:107], v11 offset:32768
    ds_read_b128 v[108:111], v12 offset:32768
    ds_read_b128 v[112:115], v13 offset:32768
L_nx5:
    s_add_u32 m0, s42, 65536
    s_nop 0
    buffer_load_dwordx4 v228, s[28:31], s40 offen offset:0 lds
    buffer_load_dwordx4 v229, s[28:31], s40 offen offset:1024 lds
    buffer_load_dwordx4 v230, s[28:31], s40 offen offset:2048 lds
    buffer_load_dwordx4 v231, s[28:31], s40 offen offset:3072 lds
    s_add_u32 m0, s42, 81920
    s_add_u32 s40, s40, 128
    buffer_load_dwordx4 v232, s[32:35], s41 offen offset:0 lds
    buffer_load_dwordx4 v233, s[32:35], s41 offen offset:1024 lds
    buffer_load_dwordx4 v234, s[32:35], s41 offen offset:2048 lds
    buffer_load_dwordx4 v235, s[32:35], s41 offen offset:3072 lds
    s_add_u32 s41, s41, 245760
    s_cmp_eq_u32 s40, 1280
    s_cselect_b32 s40, 0, s40
    s_cselect_b32 s41, 0, s41
    v_xor_b32 v10, 0x10000, v10
    v_xor_b32 v11, 0x10000, v11
    v_xor_b32 v12, 0x10000, v12
    v_xor_b32 v13, 0x10000, v13
    s_waitcnt vmcnt(8) lgkmcnt(0)
    s_barrier
    s_cbranch_vccnz L_nx6
    ds_read_b128 v[116:119], v10 offset:32768
    ds_read_b128 v[120:123], v11 offset:32768
    ds_read_b128 v[124:127], v12 offset:32768
    ds_read_b128 v[128:131], v13 offset:32768
L_nx6:
    s_add_u32 m0, s42, 0
    s_nop 0
    buffer_load_dwordx4 v228, s[28:31], s40 offen offset:0 lds
    buffer_load_dwordx4 v229, s[28:31], s40 offen offset:1024 lds
    buffer_load_dwordx4 v230, s[28:31], s40 offen offset:2048 lds
    buffer_load_dwordx4 v231, s[28:31], s40 offen offset:3072 lds
    s_add_u32 m0, s42, 16384
    s_add_u32 s40, s40, 128
    buffer_load_dwordx4 v232, s[32:35], s41 offen offset:0 lds
    buffer_load_dwordx4 v233, s[32:35], s41 offen offset:1024 lds
    buffer_load_dwordx4 v234, s[32:35], s41 offen offset:2048 lds
    buffer_load_dwordx4 v235, s[32:35], s41 offen offset:3072 lds
    s_add_u32 s41, s41, 245760
    s_cmp_eq_u32 s40, 1280
    s_cselect_b32 s40, 0, s40
    s_cselect_b32 s41, 0, s41
    s_waitcnt vmcnt(8) lgkmcnt(0)
    s_barrier
    s_cbranch_vccnz L_nx7
    ds_read_b128 v[132:135], v10 offset:0
    ds_read_b128 v[136:139], v11 offset:0
    ds_read_b128 v[140:143], v12 offset:0
    ds_read_b128 v[144:147], v13 offset:0
L_nx7:
    s_add_u32 m0, s42, 32768
    s_nop 0
    buffer_load_dwordx4 v228, s[28:31], s40 offen offset:0 lds
    buffer_load_dwordx4 v229, s[28:31], s40 offen offset:1024 lds
    buffer_load_dwordx4 v230, s[28:31], s40 offen offset:2048 lds
    buffer_load_dwordx4 v231, s[28:31], s40 offen offset:3072 lds
    s_add_u32 m0, s42, 49152
    s_add_u32 s40, s40, 128
    buffer_load_dwordx4 v232, s[32:35], s41 offen offset:0 lds
    buffer_load_dwordx4 v233, s[32:35], s41 offen offset:1024 lds
    buffer_load_dwordx4 v234, s[32:35], s41 offen offset:2048 lds
    buffer_load_dwordx4 v235, s[32:35], s41 offen offset:3072 lds
    s_add_u32 s41, s41, 245760
    s_cmp_eq_u32 s40, 1280
    s_cselect_b32 s40, 0, s40
    s_cselect_b32 s41, 0, s41
    v_xor_b32 v10, 0x10000, v10
    v_xor_b32 v11, 0x10000, v11
    v_xor_b32 v12, 0x10000, v12
    v_xor_b32 v13, 0x10000, v13
    s_waitcnt vmcnt(8) lgkmcnt(0)
    s_barrier
    s_cbranch_vccnz L_nx8
    ds_read_b128 v[148:151], v10 offset:0
    ds_read_b128 v[152:155], v11 offset:0
    ds_read_b128 v[156:159], v12 offset:0
    ds_read_b128 v[160:163], v13 offset:0
L_nx8:
    s_waitcnt vmcnt(0) lgkmcnt(0)
    s_barrier
    s_cbranch_vccnz L_nx9
    ds_read_b128 v[164:167], v10 offset:32768
    ds_read_b128 v[168:171], v11 offset:32768
    ds_read_b128 v[172:175], v12 offset:32768
    ds_read_b128 v[176:179], v13 offset:32768
L_nx9:
    s_add_u32 s55, s55, 1
    s_cmp_ge_u32 s54, 20
    s_cbranch_scc1 L_lq
    s_setprio 2
    s_mov_b32 s25, s58
    v_and_b32 v2, 31, v1
    v_and_b32 v14, 0x13, v2
    v_bfe_u32 v3, v2, 2, 1
    v_lshl_add_u32 v14, v3, 3, v14
    v_bfe_u32 v3, v2, 3, 1
    v_lshl_add_u32 v14, v3, 2, v14
    s_lshl_b32 s56, s43, 5
    v_add_u32 v14, s56, v14
    v_cvt_f32_u32 v15, v14
    v_mul_f32 v15, 0x3acccccd, v15
    v_lshrrev_b32 v16, 5, v1
    s_lshl_b32 s56, s3, 4
    v_lshl_add_u32 v16, v16, 3, s56
    s_lshl_b32 s56, s3, 11
    s_add_u32 s56, s56, 0x10000
    v_lshlrev_b32 v11, 4, v1
    v_add_u32 v10, s56, v11
    s_cmp_eq_u32 s43, 0
    s_cselect_b32 s48, 1, 0
    s_mov_b32 s49, s48
    s_mov_b32 s41, 0
    v_cos_f32 v12, v15
    s_nop 0
    v_add_f32 v12, v12, v12
    v_mov_b32 v13, v12
    s_lshr_b32 s56, s40, 1
L_wgl:
    v_add3_u32 v196, s56, v16, 0
    v_add3_u32 v212, s56, v16, 64
    v_mul_u32_u24 v196, v196, v14
    v_mul_u32_u24 v212, v212, v14
    v_cvt_f32_u32 v196, v196
    v_cvt_f32_u32 v212, v212
    v_mul_f32 v196, 0x3acccccd, v196
    v_mul_f32 v212, 0x3acccccd, v212
    v_fract_f32 v196, v196
    v_fract_f32 v212, v212
    v_add_f32 v198, v196, v15
    v_add_f32 v214, v212, v15
    v_sin_f32 v197, -v196
    v_sin_f32 v213, -v212
    v_cos_f32 v196, v196
    v_cos_f32 v212, v212
    v_sin_f32 v199, -v198
    v_sin_f32 v215, -v214
    v_cos_f32 v198, v198
    v_cos_f32 v214, v214
    v_pk_fma_f32 v[200:201], v[198:199], v[12:13], v[196:197] neg_lo:[0,0,1] neg_hi:[0,0,1]
    v_pk_fma_f32 v[216:217], v[214:215], v[12:13], v[212:213] neg_lo:[0,0,1] neg_hi:[0,0,1]
    v_pk_fma_f32 v[202:203], v[200:201], v[12:13], v[198:199] neg_lo:[0,0,1] neg_hi:[0,0,1]
    v_pk_fma_f32 v[218:219], v[216:217], v[12:13], v[214:215] neg_lo:[0,0,1] neg_hi:[0,0,1]
    v_pk_fma_f32 v[204:205], v[202:203], v[12:13], v[200:201] neg_lo:[0,0,1] neg_hi:[0,0,1]
    v_pk_fma_f32 v[220:221], v[218:219], v[12:13], v[216:217] neg_lo:[0,0,1] neg_hi:[0,0,1]
    v_pk_fma_f32 v[206:207], v[204:205], v[12:13], v[202:203] neg_lo:[0,0,1] neg_hi:[0,0,1]
    v_pk_fma_f32 v[222:223], v[220:221], v[12:13], v[218:219] neg_lo:[0,0,1] neg_hi:[0,0,1]
    v_pk_fma_f32 v[208:209], v[206:207], v[12:13], v[204:205] neg_lo:[0,0,1] neg_hi:[0,0,1]
    v_pk_fma_f32 v[224:225], v[222:223], v[12:13], v[220:221] neg_lo:[0,0,1] neg_hi:[0,0,1]
    v_pk_fma_f32 v[210:211], v[208:209], v[12:13], v[206:207] neg_lo:[0,0,1] neg_hi:[0,0,1]
    v_pk_fma_f32 v[226:227], v[224:225], v[12:13], v[222:223] neg_lo:[0,0,1] neg_hi:[0,0,1]
    s_waitcnt lgkmcnt(0)
    v_cvt_pk_bf16_f32 v228, v196, v198
    v_cvt_pk_bf16_f32 v229, v200, v202
    v_cvt_pk_bf16_f32 v230, v204, v206
    v_cvt_pk_bf16_f32 v231, v208, v210
    v_cvt_pk_bf16_f32 v232, v197, v199
    v_cvt_pk_bf16_f32 v233, v201, v203
    v_cvt_pk_bf16_f32 v234, v205, v207
    v_cvt_pk_bf16_f32 v235, v209, v211
    s_mov_b64 exec, s[48:49]
    v_mov_b32 v232, 0xbf803f80
    v_mov_b32 v233, 0xbf803f80
    v_mov_b32 v234, 0xbf803f80
    v_mov_b32 v235, 0xbf803f80
    s_mov_b64 exec, -1
    ds_write_b128 v10, v[228:231] offset:0
    ds_write_b128 v10, v[232:235] offset:1024
    v_cvt_pk_bf16_f32 v236, v212, v214
    v_cvt_pk_bf16_f32 v237, v216, v218
    v_cvt_pk_bf16_f32 v238, v220, v222
    v_cvt_pk_bf16_f32 v239, v224, v226
    v_cvt_pk_bf16_f32 v240, v213, v215
    v_cvt_pk_bf16_f32 v241, v217, v219
    v_cvt_pk_bf16_f32 v242, v221, v223
    v_cvt_pk_bf16_f32 v243, v225, v227
    s_mov_b64 exec, s[48:49]
    v_mov_b32 v240, 0xbf803f80
    v_mov_b32 v241, 0xbf803f80
    v_mov_b32 v242, 0xbf803f80
    v_mov_b32 v243, 0xbf803f80
    s_mov_b64 exec, -1
    ds_write_b128 v10, v[236:239] offset:8192
    ds_write_b128 v10, v[240:243] offset:9216
    v_add_u32 v10, 16384, v10
    s_add_u32 s56, s56, 128
    s_cmp_ge_u32 s56, 640
    s_cselect_b32 s57, 640, 0
    s_sub_u32 s56, s56, s57
    s_add_u32 s41, s41, 1
    s_cmp_lg_u32 s41, 5
    s_cbranch_scc1 L_wgl
    s_waitcnt lgkmcnt(0)
    v_mov_b32 v2, 1
    s_mov_b64 exec, 1
    ds_add_u32 v8, v2 offset:12
    s_mov_b64 exec, -1
    v_and_b32 v4, 31, v1
    v_cvt_f32_u32 v15, v4
    v_mul_f32 v15, 0x3d000000, v15
    v_and_b32 v16, 8, v16
    v_cos_f32 v12, v15
    s_nop 0
    v_add_f32 v12, v12, v12
    v_mov_b32 v13, v12
    v_add_u32 v196, 0, v16
    v_add_u32 v212, 16, v16
    v_cvt_f32_u32 v196, v196
    v_cvt_f32_u32 v212, v212
    v_mul_f32 v196, v196, v15
    v_mul_f32 v212, v212, v15
    v_fract_f32 v196, v196
    v_fract_f32 v212, v212
    v_add_f32 v198, v196, v15
    v_add_f32 v214, v212, v15
    v_sin_f32 v197, -v196
    v_sin_f32 v213, -v212
    v_cos_f32 v196, v196
    v_cos_f32 v212, v212
    v_sin_f32 v199, -v198
    v_sin_f32 v215, -v214
    v_cos_f32 v198, v198
    v_cos_f32 v214, v214
    v_pk_fma_f32 v[200:201], v[198:199], v[12:13], v[196:197] neg_lo:[0,0,1] neg_hi:[0,0,1]
    v_pk_fma_f32 v[216:217], v[214:215], v[12:13], v[212:213] neg_lo:[0,0,1] neg_hi:[0,0,1]
    v_pk_fma_f32 v[202:203], v[200:201], v[12:13], v[198:199] neg_lo:[0,0,1] neg_hi:[0,0,1]
    v_pk_fma_f32 v[218:219], v[216:217], v[12:13], v[214:215] neg_lo:[0,0,1] neg_hi:[0,0,1]
    v_pk_fma_f32 v[204:205], v[202:203], v[12:13], v[200:201] neg_lo:[0,0,1] neg_hi:[0,0,1]
    v_pk_fma_f32 v[220:221], v[218:219], v[12:13], v[216:217] neg_lo:[0,0,1] neg_hi:[0,0,1]
    v_pk_fma_f32 v[206:207], v[204:205], v[12:13], v[202:203] neg_lo:[0,0,1] neg_hi:[0,0,1]
    v_pk_fma_f32 v[222:223], v[220:221], v[12:13], v[218:219] neg_lo:[0,0,1] neg_hi:[0,0,1]
    v_pk_fma_f32 v[208:209], v[206:207], v[12:13], v[204:205] neg_lo:[0,0,1] neg_hi:[0,0,1]
    v_pk_fma_f32 v[224:225], v[222:223], v[12:13], v[220:221] neg_lo:[0,0,1] neg_hi:[0,0,1]
    v_pk_fma_f32 v[210:211], v[208:209], v[12:13], v[206:207] neg_lo:[0,0,1] neg_hi:[0,0,1]
    v_pk_fma_f32 v[226:227], v[224:225], v[12:13], v[222:223] neg_lo:[0,0,1] neg_hi:[0,0,1]
    v_cvt_pk_bf16_f32 v180, v196, v198
    v_cvt_pk_bf16_f32 v184, v212, v214
    v_cvt_pk_bf16_f32 v181, v200, v202
    v_cvt_pk_bf16_f32 v185, v216, v218
    v_cvt_pk_bf16_f32 v182, v204, v206
    v_cvt_pk_bf16_f32 v186, v220, v222
    v_cvt_pk_bf16_f32 v183, v208, v210
    v_cvt_pk_bf16_f32 v187, v224, v226
    v_cvt_pk_bf16_f32 v188, v197, v199
    v_cvt_pk_bf16_f32 v192, v213, v215
    v_cvt_pk_bf16_f32 v189, v201, v203
    v_cvt_pk_bf16_f32 v193, v217, v219
    v_cvt_pk_bf16_f32 v190, v205, v207
    v_cvt_pk_bf16_f32 v194, v221, v223
    v_cvt_pk_bf16_f32 v191, v209, v211
    v_cvt_pk_bf16_f32 v195, v225, v227
    v_add_u32 v10, 0x10000, v11
    v_add_u32 v11, 0x20000, v11
    s_setprio 3
    s_mov_b32 s59, 1600000
L_f1:
    ds_read_b32 v2, v8 offset:12
    s_waitcnt lgkmcnt(0)
    v_readfirstlane_b32 s56, v2
    s_nop 1
    s_cmp_eq_u32 s56, 4
    s_cbranch_scc0 L_f1s
L_f1d:
    ds_read_b128 v[228:231], v10 offset:0
    ds_read_b128 v[232:235], v10 offset:1024
    ds_read_b128 v[236:239], v10 offset:2048
    ds_read_b128 v[240:243], v10 offset:3072
    ds_read_b128 v[244:247], v10 offset:4096
    ds_read_b128 v[248:251], v10 offset:5120
    s_waitcnt lgkmcnt(4)
    v_mfma_f32_32x32x16_bf16 v[196:211], v[20:23], v[228:231], 0
    v_mfma_f32_32x32x16_bf16 v[212:227], v[20:23], v[232:235], 0
    ds_read_b128 v[228:231], v10 offset:6144
    ds_read_b128 v[232:235], v10 offset:7168
    s_waitcnt lgkmcnt(4)
    v_mfma_f32_32x32x16_bf16 v[196:211], v[24:27], v[236:239], v[196:211]
    v_mfma_f32_32x32x16_bf16 v[212:227], v[24:27], v[240:243], v[212:227]
    ds_read_b128 v[236:239], v10 offset:8192
    ds_read_b128 v[240:243], v10 offset:9216
    s_waitcnt lgkmcnt(4)
    v_mfma_f32_32x32x16_bf16 v[196:211], v[28:31], v[244:247], v[196:211]
    v_mfma_f32_32x32x16_bf16 v[212:227], v[28:31], v[248:251], v[212:227]
    ds_read_b128 v[244:247], v10 offset:10240
    ds_read_b128 v[248:251], v10 offset:11264
    s_waitcnt lgkmcnt(4)
    v_mfma_f32_32x32x16_bf16 v[196:211], v[32:35], v[228:231], v[196:211]
    v_mfma_f32_32x32x16_bf16 v[212:227], v[32:35], v[232:235], v[212:227]
    ds_read_b128 v[228:231], v10 offset:12288
    ds_read_b128 v[232:235], v10 offset:13312
    s_waitcnt lgkmcnt(4)
    v_mfma_f32_32x32x16_bf16 v[196:211], v[36:39], v[236:239], v[196:211]
    v_mfma_f32_32x32x16_bf16 v[212:227], v[36:39], v[240:243], v[212:227]
    ds_read_b128 v[236:239], v10 offset:14336
    ds_read_b128 v[240:243], v10 offset:15360
    s_waitcnt lgkmcnt(4)
    v_mfma_f32_32x32x16_bf16 v[196:211], v[40:43], v[244:247], v[196:211]
    v_mfma_f32_32x32x16_bf16 v[212:227], v[40:43], v[248:251], v[212:227]
    ds_read_b128 v[244:247], v10 offset:16384
    ds_read_b128 v[248:251], v10 offset:17408
    s_waitcnt lgkmcnt(4)
    v_mfma_f32_32x32x16_bf16 v[196:211], v[44:47], v[228:231], v[196:211]
    v_mfma_f32_32x32x16_bf16 v[212:227], v[44:47], v[232:235], v[212:227]
    ds_read_b128 v[228:231], v10 offset:18432
    ds_read_b128 v[232:235], v10 offset:19456
    s_waitcnt lgkmcnt(4)
    v_mfma_f32_32x32x16_bf16 v[196:211], v[48:51], v[236:239], v[196:211]
    v_mfma_f32_32x32x16_bf16 v[212:227], v[48:51], v[240:243], v[212:227]
    ds_read_b128 v[236:239], v10 offset:20480
    ds_read_b128 v[240:243], v10 offset:21504
    s_waitcnt lgkmcnt(4)
    v_mfma_f32_32x32x16_bf16 v[196:211], v[52:55], v[244:247], v[196:211]
    v_mfma_f32_32x32x16_bf16 v[212:227], v[52:55], v[248:251], v[212:227]
    ds_read_b128 v[244:247], v10 offset:22528
    ds_read_b128 v[248:251], v10 offset:23552
    s_waitcnt lgkmcnt(4)
    v_mfma_f32_32x32x16_bf16 v[196:211], v[56:59], v[228:231], v[196:211]
    v_mfma_f32_32x32x16_bf16 v[212:227], v[56:59], v[232:235], v[212:227]
    ds_read_b128 v[228:231], v10 offset:24576
    ds_read_b128 v[232:235], v10 offset:25600
    s_waitcnt lgkmcnt(4)
    v_mfma_f32_32x32x16_bf16 v[196:211], v[60:63], v[236:239], v[196:211]
    v_mfma_f32_32x32x16_bf16 v[212:227], v[60:63], v[240:243], v[212:227]
    ds_read_b128 v[236:239], v10 offset:26624
    ds_read_b128 v[240:243], v10 offset:27648
    s_waitcnt lgkmcnt(4)
    v_mfma_f32_32x32x16_bf16 v[196:211], v[64:67], v[244:247], v[196:211]
    v_mfma_f32_32x32x16_bf16 v[212:227], v[64:67], v[248:251], v[212:227]
    ds_read_b128 v[244:247], v10 offset:28672
    ds_read_b128 v[248:251], v10 offset:29696
    s_waitcnt lgkmcnt(4)
    v_mfma_f32_32x32x16_bf16 v[196:211], v[68:71], v[228:231], v[196:211]
    v_mfma_f32_32x32x16_bf16 v[212:227], v[68:71], v[232:235], v[212:227]
    ds_read_b128 v[228:231], v10 offset:30720
    ds_read_b128 v[232:235], v10 offset:31744
    s_waitcnt lgkmcnt(4)
    v_mfma_f32_32x32x16_bf16 v[196:211], v[72:75], v[236:239], v[196:211]
    v_mfma_f32_32x32x16_bf16 v[212:227], v[72:75], v[240:243], v[212:227]
    ds_read_b128 v[236:239], v10 offset:32768
    ds_read_b128 v[240:243], v10 offset:33792
    s_waitcnt lgkmcnt(4)
    v_mfma_f32_32x32x16_bf16 v[196:211], v[76:79], v[244:247], v[196:211]
    v_mfma_f32_32x32x16_bf16 v[212:227], v[76:79], v[248:251], v[212:227]
    ds_read_b128 v[244:247], v10 offset:34816
    ds_read_b128 v[248:251], v10 offset:35840
    s_waitcnt lgkmcnt(4)
    v_mfma_f32_32x32x16_bf16 v[196:211], v[80:83], v[228:231], v[196:211]
    v_mfma_f32_32x32x16_bf16 v[212:227], v[80:83], v[232:235], v[212:227]
    ds_read_b128 v[228:231], v10 offset:36864
    ds_read_b128 v[232:235], v10 offset:37888
    s_waitcnt lgkmcnt(4)
    v_mfma_f32_32x32x16_bf16 v[196:211], v[84:87], v[236:239], v[196:211]
    v_mfma_f32_32x32x16_bf16 v[212:227], v[84:87], v[240:243], v[212:227]
    ds_read_b128 v[236:239], v10 offset:38912
    ds_read_b128 v[240:243], v10 offset:39936
    s_waitcnt lgkmcnt(4)
    v_mfma_f32_32x32x16_bf16 v[196:211], v[88:91], v[244:247], v[196:211]
    v_mfma_f32_32x32x16_bf16 v[212:227], v[88:91], v[248:251], v[212:227]
    ds_read_b128 v[244:247], v10 offset:40960
    ds_read_b128 v[248:251], v10 offset:41984
    s_waitcnt lgkmcnt(4)
    v_mfma_f32_32x32x16_bf16 v[196:211], v[92:95], v[228:231], v[196:211]
    v_mfma_f32_32x32x16_bf16 v[212:227], v[92:95], v[232:235], v[212:227]
    ds_read_b128 v[228:231], v10 offset:43008
    ds_read_b128 v[232:235], v10 offset:44032
    s_waitcnt lgkmcnt(4)
    v_mfma_f32_32x32x16_bf16 v[196:211], v[96:99], v[236:239], v[196:211]
    v_mfma_f32_32x32x16_bf16 v[212:227], v[96:99], v[240:243], v[212:227]
    ds_read_b128 v[236:239], v10 offset:45056
    ds_read_b128 v[240:243], v10 offset:46080
    s_waitcnt lgkmcnt(4)
    v_mfma_f32_32x32x16_bf16 v[196:211], v[100:103], v[244:247], v[196:211]
    v_mfma_f32_32x32x16_bf16 v[212:227], v[100:103], v[248:251], v[212:227]
    ds_read_b128 v[244:247], v10 offset:47104
    ds_read_b128 v[248:251], v10 offset:48128
    s_waitcnt lgkmcnt(4)
    v_mfma_f32_32x32x16_bf16 v[196:211], v[104:107], v[228:231], v[196:211]
    v_mfma_f32_32x32x16_bf16 v[212:227], v[104:107], v[232:235], v[212:227]
    ds_read_b128 v[228:231], v10 offset:49152
    ds_read_b128 v[232:235], v10 offset:50176
    s_waitcnt lgkmcnt(4)
    v_mfma_f32_32x32x16_bf16 v[196:211], v[108:111], v[236:239], v[196:211]
    v_mfma_f32_32x32x16_bf16 v[212:227], v[108:111], v[240:243], v[212:227]
    ds_read_b128 v[236:239], v10 offset:51200
    ds_read_b128 v[240:243], v10 offset:52224
    s_waitcnt lgkmcnt(4)
    v_mfma_f32_32x32x16_bf16 v[196:211], v[112:115], v[244:247], v[196:211]
    v_mfma_f32_32x32x16_bf16 v[212:227], v[112:115], v[248:251], v[212:227]
    ds_read_b128 v[244:247], v10 offset:53248
    ds_read_b128 v[248:251], v10 offset:54272
    s_waitcnt lgkmcnt(4)
    v_mfma_f32_32x32x16_bf16 v[196:211], v[116:119], v[228:231], v[196:211]
    v_mfma_f32_32x32x16_bf16 v[212:227], v[116:119], v[232:235], v[212:227]
    ds_read_b128 v[228:231], v10 offset:55296
    ds_read_b128 v[232:235], v10 offset:56320
    s_waitcnt lgkmcnt(4)
    v_mfma_f32_32x32x16_bf16 v[196:211], v[120:123], v[236:239], v[196:211]
    v_mfma_f32_32x32x16_bf16 v[212:227], v[120:123], v[240:243], v[212:227]
    ds_read_b128 v[236:239], v10 offset:57344
    ds_read_b128 v[240:243], v10 offset:58368
    s_waitcnt lgkmcnt(4)
    v_mfma_f32_32x32x16_bf16 v[196:211], v[124:127], v[244:247], v[196:211]
    v_mfma_f32_32x32x16_bf16 v[212:227], v[124:127], v[248:251], v[212:227]
    ds_read_b128 v[244:247], v10 offset:59392
    ds_read_b128 v[248:251], v10 offset:60416
    s_waitcnt lgkmcnt(4)
    v_mfma_f32_32x32x16_bf16 v[196:211], v[128:131], v[228:231], v[196:211]
    v_mfma_f32_32x32x16_bf16 v[212:227], v[128:131], v[232:235], v[212:227]
    ds_read_b128 v[228:231], v10 offset:61440
    ds_read_b128 v[232:235], v10 offset:62464
    s_waitcnt lgkmcnt(4)
    v_mfma_f32_32x32x16_bf16 v[196:211], v[132:135], v[236:239], v[196:211]
    v_mfma_f32_32x32x16_bf16 v[212:227], v[132:135], v[240:243], v[212:227]
    ds_read_b128 v[236:239], v10 offset:63488
    ds_read_b128 v[240:243], v10 offset:64512
    s_waitcnt lgkmcnt(4)
    v_mfma_f32_32x32x16_bf16 v[196:211], v[136:139], v[244:247], v[196:211]
    v_mfma_f32_32x32x16_bf16 v[212:227], v[136:139], v[248:251], v[212:227]
    ds_read_b128 v[244:247], v11 offset:0
    ds_read_b128 v[248:251], v11 offset:1024
    s_waitcnt lgkmcnt(4)
    v_mfma_f32_32x32x16_bf16 v[196:211], v[140:143], v[228:231], v[196:211]
    v_mfma_f32_32x32x16_bf16 v[212:227], v[140:143], v[232:235], v[212:227]
    ds_read_b128 v[228:231], v11 offset:2048
    ds_read_b128 v[232:235], v11 offset:3072
    s_waitcnt lgkmcnt(4)
    v_mfma_f32_32x32x16_bf16 v[196:211], v[144:147], v[236:239], v[196:211]
    v_mfma_f32_32x32x16_bf16 v[212:227], v[144:147], v[240:243], v[212:227]
    ds_read_b128 v[236:239], v11 offset:4096
    ds_read_b128 v[240:243], v11 offset:5120
    s_waitcnt lgkmcnt(4)
    v_mfma_f32_32x32x16_bf16 v[196:211], v[148:151], v[244:247], v[196:211]
    v_mfma_f32_32x32x16_bf16 v[212:227], v[148:151], v[248:251], v[212:227]
    ds_read_b128 v[244:247], v11 offset:6144
    ds_read_b128 v[248:251], v11 offset:7168
    s_waitcnt lgkmcnt(4)
    v_mfma_f32_32x32x16_bf16 v[196:211], v[152:155], v[228:231], v[196:211]
    v_mfma_f32_32x32x16_bf16 v[212:227], v[152:155], v[232:235], v[212:227]
    ds_read_b128 v[228:231], v11 offset:8192
    ds_read_b128 v[232:235], v11 offset:9216
    s_waitcnt lgkmcnt(4)
    v_mfma_f32_32x32x16_bf16 v[196:211], v[156:159], v[236:239], v[196:211]
    v_mfma_f32_32x32x16_bf16 v[212:227], v[156:159], v[240:243], v[212:227]
    ds_read_b128 v[236:239], v11 offset:10240
    ds_read_b128 v[240:243], v11 offset:11264
    s_waitcnt lgkmcnt(4)
    v_mfma_f32_32x32x16_bf16 v[196:211], v[160:163], v[244:247], v[196:211]
    v_mfma_f32_32x32x16_bf16 v[212:227], v[160:163], v[248:251], v[212:227]
    ds_read_b128 v[244:247], v11 offset:12288
    ds_read_b128 v[248:251], v11 offset:13312
    s_waitcnt lgkmcnt(4)
    v_mfma_f32_32x32x16_bf16 v[196:211], v[164:167], v[228:231], v[196:211]
    v_mfma_f32_32x32x16_bf16 v[212:227], v[164:167], v[232:235], v[212:227]
    ds_read_b128 v[228:231], v11 offset:14336
    ds_read_b128 v[232:235], v11 offset:15360
    s_waitcnt lgkmcnt(4)
    v_mfma_f32_32x32x16_bf16 v[196:211], v[168:171], v[236:239], v[196:211]
    v_mfma_f32_32x32x16_bf16 v[212:227], v[168:171], v[240:243], v[212:227]
    s_waitcnt lgkmcnt(2)
    v_mfma_f32_32x32x16_bf16 v[196:211], v[172:175], v[244:247], v[196:211]
    v_mfma_f32_32x32x16_bf16 v[212:227], v[172:175], v[248:251], v[212:227]
    s_waitcnt lgkmcnt(0)
    v_mfma_f32_32x32x16_bf16 v[196:211], v[176:179], v[228:231], v[196:211]
    v_mfma_f32_32x32x16_bf16 v[212:227], v[176:179], v[232:235], v[212:227]
    v_mov_b32 v2, 1
    s_mov_b64 exec, 1
    ds_add_u32 v8, v2 offset:8
    s_mov_b64 exec, -1
    s_waitcnt vmcnt(0)
    v_xor_b32 v20, 0x80008000, v180
    v_xor_b32 v188, 0x80008000, v188
    v_xor_b32 v21, 0x80008000, v181
    v_xor_b32 v189, 0x80008000, v189
    v_xor_b32 v22, 0x80008000, v182
    v_xor_b32 v190, 0x80008000, v190
    v_xor_b32 v23, 0x80008000, v183
    v_xor_b32 v191, 0x80008000, v191
    v_xor_b32 v24, 0x80008000, v184
    v_xor_b32 v192, 0x80008000, v192
    v_xor_b32 v25, 0x80008000, v185
    v_xor_b32 v193, 0x80008000, v193
    v_xor_b32 v26, 0x80008000, v186
    v_xor_b32 v194, 0x80008000, v194
    v_xor_b32 v27, 0x80008000, v187
    v_xor_b32 v195, 0x80008000, v195
    v_cvt_pk_bf16_f32 v196, v196, v197
    v_cvt_pk_bf16_f32 v197, v198, v199
    v_cvt_pk_bf16_f32 v198, v200, v201
    v_cvt_pk_bf16_f32 v199, v202, v203
    v_cvt_pk_bf16_f32 v200, v204, v205
    v_cvt_pk_bf16_f32 v201, v206, v207
    v_cvt_pk_bf16_f32 v202, v208, v209
    v_cvt_pk_bf16_f32 v203, v210, v211
    v_cvt_pk_bf16_f32 v212, v212, v213
    v_cvt_pk_bf16_f32 v213, v214, v215
    v_cvt_pk_bf16_f32 v214, v216, v217
    v_cvt_pk_bf16_f32 v215, v218, v219
    v_cvt_pk_bf16_f32 v216, v220, v221
    v_cvt_pk_bf16_f32 v217, v222, v223
    v_cvt_pk_bf16_f32 v218, v224, v225
    v_cvt_pk_bf16_f32 v219, v226, v227
    s_nop 0
    s_cmp_lg_u32 s43, 0
    s_cbranch_scc1 L_fn
    v_mfma_f32_32x32x16_bf16 v[68:83], v[212:215], v[180:183], 0
    v_mfma_f32_32x32x16_bf16 v[68:83], v[216:219], v[184:187], v[68:83]
    v_mfma_f32_32x32x16_bf16 v[84:99], v[212:215], v[188:191], 0
    v_mfma_f32_32x32x16_bf16 v[84:99], v[216:219], v[192:195], v[84:99]
    s_mov_b32 exec_lo, 1
    s_mov_b32 exec_hi, 1
    v_mov_b32 v212, 0
    v_mov_b32 v213, 0
    v_mov_b32 v214, 0
    v_mov_b32 v215, 0
    v_mov_b32 v216, 0
    v_mov_b32 v217, 0
    v_mov_b32 v218, 0
    v_mov_b32 v219, 0
    s_mov_b64 exec, s[60:61]
    s_nop 3
    v_mov_b32 v248, 0
    v_mov_b32 v252, 0
    v_mov_b32 v249, 0
    v_mov_b32 v253, 0
    v_mov_b32 v250, 0
    v_mov_b32 v254, 0
    v_mov_b32 v251, 0
    v_mov_b32 v255, 0
    v_cvt_pk_bf16_f32 v248, v68, 0
    v_cvt_pk_bf16_f32 v252, v84, 0
    s_mov_b64 exec, -1
L_fn:
    v_mfma_f32_32x32x16_bf16 v[36:51], v[196:199], v[180:183], 0
    v_mfma_f32_32x32x16_bf16 v[36:51], v[200:203], v[184:187], v[36:51]
    v_mfma_f32_32x32x16_bf16 v[36:51], v[212:215], v[188:191], v[36:51]
    v_mfma_f32_32x32x16_bf16 v[36:51], v[216:219], v[192:195], v[36:51]
    v_mfma_f32_32x32x16_bf16 v[52:67], v[212:215], v[20:23], 0
    v_mfma_f32_32x32x16_bf16 v[52:67], v[216:219], v[24:27], v[52:67]
    v_mfma_f32_32x32x16_bf16 v[52:67], v[196:199], v[188:191], v[52:67]
    v_mfma_f32_32x32x16_bf16 v[52:67], v[200:203], v[192:195], v[52:67]
    s_nop 7
    v_cvt_pk_bf16_f32 v232, v36, v37
    v_cvt_pk_bf16_f32 v233, v38, v39
    v_cvt_pk_bf16_f32 v234, v40, v41
    v_cvt_pk_bf16_f32 v235, v42, v43
    v_cvt_pk_bf16_f32 v236, v44, v45
    v_cvt_pk_bf16_f32 v237, v46, v47
    v_cvt_pk_bf16_f32 v238, v48, v49
    v_cvt_pk_bf16_f32 v239, v50, v51
    v_cvt_pk_bf16_f32 v240, v52, v53
    v_cvt_pk_bf16_f32 v241, v54, v55
    v_cvt_pk_bf16_f32 v242, v56, v57
    v_cvt_pk_bf16_f32 v243, v58, v59
    v_cvt_pk_bf16_f32 v244, v60, v61
    v_cvt_pk_bf16_f32 v245, v62, v63
    v_cvt_pk_bf16_f32 v246, v64, v65
    v_cvt_pk_bf16_f32 v247, v66, v67
    s_branch L_help
L_lgate:
    v_mov_b32 v9, 0
    v_mov_b32 v220, 0
    v_mov_b32 v221, 0
    v_mov_b32 v222, 0
    v_mov_b32 v223, 0
    s_mov_b32 s25, 0
    s_mov_b32 s24, 0
    s_mov_b32 s15, 0
    s_mov_b32 s44, s26
    s_and_b32 s45, s27, 0xffff
    s_mov_b32 s46, 0x49000
    s_mov_b32 s47, 0x20000
    v_mov_b32 v8, 155648
    s_mov_b32 s60, -1
    s_mov_b32 s61, 0
    s_mov_b32 s94, 0
    s_mov_b32 s95, -1
    s_mov_b32 s62, 0xfffff
    s_mov_b32 s63, 0xfffff
    s_mov_b32 s96, -1
    s_mov_b32 s97, 0xff
    s_lshl_b32 s56, s2, 3
    s_add_u32 s56, s56, s52
    s_cmp_lg_u32 s56, 1924
    s_cbranch_scc1 L_ncw
    s_add_u32 s36, s26, 0x550000
    s_addc_u32 s37, s27, 0
    s_and_b32 s37, s37, 0xffff
    s_mov_b32 s38, 0x290000
    s_mov_b32 s39, 0x20000
    v_mov_b32 v196, 0x3f803f80
    v_mov_b32 v197, 0x3f803f80
    v_mov_b32 v198, 0x3f803f80
    v_mov_b32 v199, 0x3f803f80
    v_mov_b32 v200, 0x3f803f80
    v_mov_b32 v201, 0x3f80
    v_mov_b32 v202, 0x3f803f80
    v_mov_b32 v203, 0x3f80
    v_mul_u32_u24 v4, 10368, v1
    s_mov_b32 s56, 43008
    buffer_store_dwordx4 v[196:199], v4, s[36:39], s56 offen sc1
    s_mov_b32 s56, 706560
    buffer_store_dwordx4 v[196:199], v4, s[36:39], s56 offen sc1
    s_mov_b32 s56, 1370112
    buffer_store_dwordx4 v[196:199], v4, s[36:39], s56 offen sc1
    s_mov_b32 s56, 2033664
    buffer_store_dwordx4 v[196:199], v4, s[36:39], s56 offen sc1
    v_and_b32 v4, 31, v1
    v_lshlrev_b32 v4, 10, v4
    buffer_store_dwordx4 v[200:203], v4, s[36:39], 0 offen sc1
    s_waitcnt vmcnt(0) lgkmcnt(0)
    s_add_u32 s55, s55, 1
    s_mov_b32 s56, 36864
    v_mov_b32 v2, 0
    v_mov_b32 v3, s55
    s_mov_b64 exec, 1
    buffer_store_dword v3, v2, s[44:47], s56 offen sc1
    s_mov_b64 exec, -1
    s_sub_u32 s55, s55, 1
L_ncw:
    s_mov_b32 s32, s18
    s_and_b32 s33, s19, 0xffff
    s_mov_b32 s34, 0xc8000
    s_mov_b32 s35, 0x20000
    s_add_u32 s36, s26, 0xd00000
    s_addc_u32 s37, s27, 0
    s_and_b32 s37, s37, 0xffff
    s_mov_b32 s38, 0xc8000
    s_mov_b32 s39, 0x20000
    s_and_b32 s56, s54, 1
    s_lshl_b32 s56, s56, 2
    s_add_u32 s58, s56, s3
    v_mul_u32_u24 v4, 205, v1
    v_lshrrev_b32 v4, 11, v4
    v_mul_u32_u24 v5, 1120, v4
    v_lshl_add_u32 v5, v1, 4, v5
    s_mul_i32 s56, s53, 160
    v_add_u32 v5, s56, v5
    s_mul_i32 s56, s53, 102400
    s_mul_i32 s57, s58, 12800
    s_add_u32 s56, s56, s57
    v_lshl_add_u32 v6, v1, 4, s56
    s_mul_i32 s40, s58, 5
    s_mul_i32 s41, s53, 5
    s_lshr_b32 s41, s41, 1
    s_mov_b64 exec, s[96:97]
    s_add_u32 s56, s40, 0
    s_lshr_b32 s57, s56, 1
    s_and_b32 s56, s56, 1
    s_lshl_b32 s57, s57, 3
    s_add_u32 s56, s56, s57
    s_mul_i32 s56, s56, 5120
    buffer_load_dwordx4 v[20:23], v5, s[32:35], s56 offen
    s_add_u32 s56, s56, 10240
    buffer_load_dwordx4 v[24:27], v5, s[32:35], s56 offen
    s_add_u32 s56, s56, 10240
    buffer_load_dwordx4 v[28:31], v5, s[32:35], s56 offen
    s_add_u32 s56, s56, 10240
    buffer_load_dwordx4 v[32:35], v5, s[32:35], s56 offen
    s_add_u32 s56, s40, 1
    s_lshr_b32 s57, s56, 1
    s_and_b32 s56, s56, 1
    s_lshl_b32 s57, s57, 3
    s_add_u32 s56, s56, s57
    s_mul_i32 s56, s56, 5120
    buffer_load_dwordx4 v[36:39], v5, s[32:35], s56 offen
    s_add_u32 s56, s56, 10240
    buffer_load_dwordx4 v[40:43], v5, s[32:35], s56 offen
    s_add_u32 s56, s56, 10240
    buffer_load_dwordx4 v[44:47], v5, s[32:35], s56 offen
    s_add_u32 s56, s56, 10240
    buffer_load_dwordx4 v[48:51], v5, s[32:35], s56 offen
    s_add_u32 s56, s40, 2
    s_lshr_b32 s57, s56, 1
    s_and_b32 s56, s56, 1
    s_lshl_b32 s57, s57, 3
    s_add_u32 s56, s56, s57
    s_mul_i32 s56, s56, 5120
    buffer_load_dwordx4 v[52:55], v5, s[32:35], s56 offen
    s_add_u32 s56, s56, 10240
    buffer_load_dwordx4 v[56:59], v5, s[32:35], s56 offen
    s_add_u32 s56, s56, 10240
    buffer_load_dwordx4 v[60:63], v5, s[32:35], s56 offen
    s_add_u32 s56, s56, 10240
    buffer_load_dwordx4 v[64:67], v5, s[32:35], s56 offen
    s_add_u32 s56, s40, 3
    s_lshr_b32 s57, s56, 1
    s_and_b32 s56, s56, 1
    s_lshl_b32 s57, s57, 3
    s_add_u32 s56, s56, s57
    s_mul_i32 s56, s56, 5120
    buffer_load_dwordx4 v[68:71], v5, s[32:35], s56 offen
    s_add_u32 s56, s56, 10240
    buffer_load_dwordx4 v[72:75], v5, s[32:35], s56 offen
    s_add_u32 s56, s56, 10240
    buffer_load_dwordx4 v[76:79], v5, s[32:35], s56 offen
    s_add_u32 s56, s56, 10240
    buffer_load_dwordx4 v[80:83], v5, s[32:35], s56 offen
    s_add_u32 s56, s40, 4
    s_lshr_b32 s57, s56, 1
    s_and_b32 s56, s56, 1
    s_lshl_b32 s57, s57, 3
    s_add_u32 s56, s56, s57
    s_mul_i32 s56, s56, 5120
    buffer_load_dwordx4 v[84:87], v5, s[32:35], s56 offen
    s_add_u32 s56, s56, 10240
    buffer_load_dwordx4 v[88:91], v5, s[32:35], s56 offen
    s_add_u32 s56, s56, 10240
    buffer_load_dwordx4 v[92:95], v5, s[32:35], s56 offen
    s_add_u32 s56, s56, 10240
    buffer_load_dwordx4 v[96:99], v5, s[32:35], s56 offen
    s_mov_b64 exec, -1
    s_waitcnt lgkmcnt(0)
    s_barrier
    s_add_u32 s55, s55, 1
    s_mov_b64 exec, s[96:97]
    s_waitcnt vmcnt(0)
    s_mov_b32 s56, 0
    buffer_store_dwordx4 v[20:23], v6, s[36:39], s56 offen offset:0 sc1
    buffer_store_dwordx4 v[24:27], v6, s[36:39], s56 offen offset:640 sc1
    buffer_store_dwordx4 v[28:31], v6, s[36:39], s56 offen offset:1280 sc1
    buffer_store_dwordx4 v[32:35], v6, s[36:39], s56 offen offset:1920 sc1
    s_mov_b32 s56, 2560
    buffer_store_dwordx4 v[36:39], v6, s[36:39], s56 offen offset:0 sc1
    buffer_store_dwordx4 v[40:43], v6, s[36:39], s56 offen offset:640 sc1
    buffer_store_dwordx4 v[44:47], v6, s[36:39], s56 offen offset:1280 sc1
    buffer_store_dwordx4 v[48:51], v6, s[36:39], s56 offen offset:1920 sc1
    s_mov_b32 s56, 5120
    buffer_store_dwordx4 v[52:55], v6, s[36:39], s56 offen offset:0 sc1
    buffer_store_dwordx4 v[56:59], v6, s[36:39], s56 offen offset:640 sc1
    buffer_store_dwordx4 v[60:63], v6, s[36:39], s56 offen offset:1280 sc1
    buffer_store_dwordx4 v[64:67], v6, s[36:39], s56 offen offset:1920 sc1
    s_mov_b32 s56, 7680
    buffer_store_dwordx4 v[68:71], v6, s[36:39], s56 offen offset:0 sc1
    buffer_store_dwordx4 v[72:75], v6, s[36:39], s56 offen offset:640 sc1
    buffer_store_dwordx4 v[76:79], v6, s[36:39], s56 offen offset:1280 sc1
    buffer_store_dwordx4 v[80:83], v6, s[36:39], s56 offen offset:1920 sc1
    s_mov_b32 s56, 10240
    buffer_store_dwordx4 v[84:87], v6, s[36:39], s56 offen offset:0 sc1
    buffer_store_dwordx4 v[88:91], v6, s[36:39], s56 offen offset:640 sc1
    buffer_store_dwordx4 v[92:95], v6, s[36:39], s56 offen offset:1280 sc1
    buffer_store_dwordx4 v[96:99], v6, s[36:39], s56 offen offset:1920 sc1
    s_mov_b64 exec, -1
    s_lshl_b32 s56, s53, 3
    s_add_u32 s56, s56, s58
    s_lshl_b32 s56, s56, 2
    s_add_u32 s56, s56, 53248
    s_waitcnt vmcnt(0)
    v_mov_b32 v2, 0
    v_mov_b32 v3, s55
    s_mov_b64 exec, 1
    buffer_store_dword v3, v2, s[44:47], s56 offen sc1
    s_mov_b64 exec, -1
    s_waitcnt vmcnt(0)
    s_branch L_lfree
L_lq:
    s_cmp_lg_u32 s99, 0
    s_cbranch_scc1 L_lfree
    s_mov_b32 s59, 1600000
L_g0:
    ds_read_b32 v2, v8 offset:20
    s_waitcnt lgkmcnt(0)
    v_readfirstlane_b32 s56, v2
    s_nop 1
    s_cmp_eq_u32 s56, 4
    s_cbranch_scc0 L_g0s
L_g0d:
    s_mov_b32 s32, s20
    s_and_b32 s33, s21, 0xffff
    s_mov_b32 s34, 0x500
    s_mov_b32 s35, 0x20000
    s_mul_i32 s42, s52, 3072
    s_add_u32 s42, s42, 131072
    v_lshlrev_b32 v2, 4, v1
    v_subrev_u32 v3, 1280, v2
    v_min_u32 v2, v2, v3
    s_add_u32 m0, s42, 0
    s_nop 0
    buffer_load_dwordx4 v2, s[32:35], 0 offen lds
    v_lshlrev_b32 v2, 4, v1
    v_add_u32 v2, 1024, v2
    v_subrev_u32 v3, 1280, v2
    v_min_u32 v2, v2, v3
    s_add_u32 m0, s42, 1024
    s_nop 0
    buffer_load_dwordx4 v2, s[32:35], 0 offen lds
    v_lshlrev_b32 v2, 4, v1
    v_add_u32 v2, 2048, v2
    v_subrev_u32 v3, 1280, v2
    v_min_u32 v2, v2, v3
    s_add_u32 m0, s42, 2048
    s_nop 0
    buffer_load_dwordx4 v2, s[32:35], 0 offen lds
    v_lshrrev_b32 v4, 5, v1
    s_add_u32 s56, s42, s40
    v_lshl_add_u32 v4, v4, 4, s56
    s_add_u32 s36, s26, 0x49000
    s_addc_u32 s37, s27, 0
    s_and_b32 s37, s37, 0xffff
    s_mov_b32 s38, 0x4000
    s_mov_b32 s39, 0x20000
    s_lshl_b32 s58, s98, 2
    s_add_u32 s58, s58, s3
    s_waitcnt vmcnt(0)
    ds_read_b128 v[228:231], v4 offset:0
    ds_read_b128 v[232:235], v4 offset:32
    ds_read_b128 v[236:239], v4 offset:64
    ds_read_b128 v[240:243], v4 offset:96
    ds_read_b128 v[244:247], v4 offset:128
    ds_read_b128 v[248:251], v4 offset:160
    s_waitcnt lgkmcnt(5)
    v_mfma_f32_32x32x16_bf16 v[196:211], v[228:231], v[20:23], 0
    ds_read_b128 v[228:231], v4 offset:192
    s_waitcnt lgkmcnt(5)
    v_mfma_f32_32x32x16_bf16 v[196:211], v[232:235], v[24:27], v[196:211]
    ds_read_b128 v[232:235], v4 offset:224
    s_waitcnt lgkmcnt(5)
    v_mfma_f32_32x32x16_bf16 v[196:211], v[236:239], v[28:31], v[196:211]
    ds_read_b128 v[236:239], v4 offset:256
    s_waitcnt lgkmcnt(5)
    v_mfma_f32_32x32x16_bf16 v[196:211], v[240:243], v[32:35], v[196:211]
    ds_read_b128 v[240:243], v4 offset:288
    s_waitcnt lgkmcnt(5)
    v_mfma_f32_32x32x16_bf16 v[196:211], v[244:247], v[36:39], v[196:211]
    ds_read_b128 v[244:247], v4 offset:320
    s_waitcnt lgkmcnt(5)
    v_mfma_f32_32x32x16_bf16 v[196:211], v[248:251], v[40:43], v[196:211]
    ds_read_b128 v[248:251], v4 offset:352
    s_waitcnt lgkmcnt(5)
    v_mfma_f32_32x32x16_bf16 v[196:211], v[228:231], v[44:47], v[196:211]
    ds_read_b128 v[228:231], v4 offset:384
    s_waitcnt lgkmcnt(5)
    v_mfma_f32_32x32x16_bf16 v[196:211], v[232:235], v[48:51], v[196:211]
    ds_read_b128 v[232:235], v4 offset:416
    s_waitcnt lgkmcnt(5)
    v_mfma_f32_32x32x16_bf16 v[196:211], v[236:239], v[52:55], v[196:211]
    ds_read_b128 v[236:239], v4 offset:448
    s_waitcnt lgkmcnt(5)
    v_mfma_f32_32x32x16_bf16 v[196:211], v[240:243], v[56:59], v[196:211]
    ds_read_b128 v[240:243], v4 offset:480
    s_waitcnt lgkmcnt(5)
    v_mfma_f32_32x32x16_bf16 v[196:211], v[244:247], v[60:63], v[196:211]
    ds_read_b128 v[244:247], v4 offset:512
    s_waitcnt lgkmcnt(5)
    v_mfma_f32_32x32x16_bf16 v[196:211], v[248:251], v[64:67], v[196:211]
    ds_read_b128 v[248:251], v4 offset:544
    s_waitcnt lgkmcnt(5)
    v_mfma_f32_32x32x16_bf16 v[196:211], v[228:231], v[68:71], v[196:211]
    ds_read_b128 v[228:231], v4 offset:576
    s_waitcnt lgkmcnt(5)
    v_mfma_f32_32x32x16_bf16 v[196:211], v[232:235], v[72:75], v[196:211]
    ds_read_b128 v[232:235], v4 offset:608
    s_waitcnt lgkmcnt(5)
    v_mfma_f32_32x32x16_bf16 v[196:211], v[236:239], v[76:79], v[196:211]
    ds_read_b128 v[236:239], v4 offset:640
    s_waitcnt lgkmcnt(5)
    v_mfma_f32_32x32x16_bf16 v[196:211], v[240:243], v[80:83], v[196:211]
    ds_read_b128 v[240:243], v4 offset:672
    s_waitcnt lgkmcnt(5)
    v_mfma_f32_32x32x16_bf16 v[196:211], v[244:247], v[84:87], v[196:211]
    ds_read_b128 v[244:247], v4 offset:704
    s_waitcnt lgkmcnt(5)
    v_mfma_f32_32x32x16_bf16 v[196:211], v[248:251], v[88:91], v[196:211]
    ds_read_b128 v[248:251], v4 offset:736
    s_waitcnt lgkmcnt(5)
    v_mfma_f32_32x32x16_bf16 v[196:211], v[228:231], v[92:95], v[196:211]
    ds_read_b128 v[228:231], v4 offset:768
    s_waitcnt lgkmcnt(5)
    v_mfma_f32_32x32x16_bf16 v[196:211], v[232:235], v[96:99], v[196:211]
    ds_read_b128 v[232:235], v4 offset:800
    s_waitcnt lgkmcnt(5)
    v_mfma_f32_32x32x16_bf16 v[196:211], v[236:239], v[100:103], v[196:211]
    ds_read_b128 v[236:239], v4 offset:832
    s_waitcnt lgkmcnt(5)
    v_mfma_f32_32x32x16_bf16 v[196:211], v[240:243], v[104:107], v[196:211]
    ds_read_b128 v[240:243], v4 offset:864
    s_waitcnt lgkmcnt(5)
    v_mfma_f32_32x32x16_bf16 v[196:211], v[244:247], v[108:111], v[196:211]
    ds_read_b128 v[244:247], v4 offset:896
    s_waitcnt lgkmcnt(5)
    v_mfma_f32_32x32x16_bf16 v[196:211], v[248:251], v[112:115], v[196:211]
    ds_read_b128 v[248:251], v4 offset:928
    s_waitcnt lgkmcnt(5)
    v_mfma_f32_32x32x16_bf16 v[196:211], v[228:231], v[116:119], v[196:211]
    ds_read_b128 v[228:231], v4 offset:960
    s_waitcnt lgkmcnt(5)
    v_mfma_f32_32x32x16_bf16 v[196:211], v[232:235], v[120:123], v[196:211]
    ds_read_b128 v[232:235], v4 offset:992
    s_waitcnt lgkmcnt(5)
    v_mfma_f32_32x32x16_bf16 v[196:211], v[236:239], v[124:127], v[196:211]
    ds_read_b128 v[236:239], v4 offset:1024
    s_waitcnt lgkmcnt(5)
    v_mfma_f32_32x32x16_bf16 v[196:211], v[240:243], v[128:131], v[196:211]
    ds_read_b128 v[240:243], v4 offset:1056
    s_waitcnt lgkmcnt(5)
    v_mfma_f32_32x32x16_bf16 v[196:211], v[244:247], v[132:135], v[196:211]
    ds_read_b128 v[244:247], v4 offset:1088
    s_waitcnt lgkmcnt(5)
    v_mfma_f32_32x32x16_bf16 v[196:211], v[248:251], v[136:139], v[196:211]
    ds_read_b128 v[248:251], v4 offset:1120
    s_waitcnt lgkmcnt(5)
    v_mfma_f32_32x32x16_bf16 v[196:211], v[228:231], v[140:143], v[196:211]
    ds_read_b128 v[228:231], v4 offset:1152
    s_waitcnt lgkmcnt(5)
    v_mfma_f32_32x32x16_bf16 v[196:211], v[232:235], v[144:147], v[196:211]
    ds_read_b128 v[232:235], v4 offset:1184
    s_waitcnt lgkmcnt(5)
    v_mfma_f32_32x32x16_bf16 v[196:211], v[236:239], v[148:151], v[196:211]
    ds_read_b128 v[236:239], v4 offset:1216
    s_waitcnt lgkmcnt(5)
    v_mfma_f32_32x32x16_bf16 v[196:211], v[240:243], v[152:155], v[196:211]
    ds_read_b128 v[240:243], v4 offset:1248
    s_waitcnt lgkmcnt(5)
    v_mfma_f32_32x32x16_bf16 v[196:211], v[244:247], v[156:159], v[196:211]
    s_waitcnt lgkmcnt(4)
    v_mfma_f32_32x32x16_bf16 v[196:211], v[248:251], v[160:163], v[196:211]
    s_waitcnt lgkmcnt(3)
    v_mfma_f32_32x32x16_bf16 v[196:211], v[228:231], v[164:167], v[196:211]
    s_waitcnt lgkmcnt(2)
    v_mfma_f32_32x32x16_bf16 v[196:211], v[232:235], v[168:171], v[196:211]
    s_waitcnt lgkmcnt(1)
    v_mfma_f32_32x32x16_bf16 v[196:211], v[236:239], v[172:175], v[196:211]
    s_waitcnt lgkmcnt(0)
    v_mfma_f32_32x32x16_bf16 v[196:211], v[240:243], v[176:179], v[196:211]
    s_nop 12
    v_cvt_pk_bf16_f32 v196, 0, v196
    v_mul_f32 v196, 0xbfb8aa3b, v196
    v_exp_f32 v196, v196
    v_lshlrev_b32 v4, 3, v1
    v_add_f32 v196, 1.0, v196
    v_rcp_f32 v196, v196
    s_lshl_b32 s56, s58, 8
    v_cvt_pk_bf16_f32 v212, 0, v196
    v_sub_f32 v213, 1.0, v212
    v_cvt_pk_bf16_f32 v213, 0, v213
    s_mov_b64 exec, s[60:61]
    buffer_store_dwordx2 v[212:213], v4, s[36:39], s56 offen sc1
    s_mov_b64 exec, -1
    s_lshl_b32 s25, s58, 2
    s_add_u32 s25, s25, 53504
L_lfree:
    s_waitcnt lgkmcnt(0)
    v_mov_b32 v2, 1
    s_mov_b64 exec, 1
    ds_add_u32 v8, v2 offset:8
    s_mov_b64 exec, -1
    s_branch L_help
L_comp:
    s_setprio 2
    v_and_b32 v2, 31, v1
    v_lshrrev_b32 v3, 5, v1
    v_bfe_u32 v4, v1, 1, 3
    v_xor_b32 v3, v3, v4
    v_lshlrev_b32 v3, 4, v3
    v_lshl_add_u32 v2, v2, 7, v3
    s_lshl_b32 s56, s100, 13
    v_add_u32 v10, s56, v2
    v_xor_b32 v11, 32, v10
    v_xor_b32 v12, 64, v10
    v_xor_b32 v13, 96, v10
    v_mov_b32 v92, 0
    v_mov_b32 v93, 0
    v_mov_b32 v94, 0
    v_mov_b32 v95, 0
    v_mov_b32 v96, 0
    v_mov_b32 v97, 0
    v_mov_b32 v98, 0
    v_mov_b32 v99, 0
    v_mov_b32 v100, 0
    v_mov_b32 v101, 0
    v_mov_b32 v102, 0
    v_mov_b32 v103, 0
    v_mov_b32 v104, 0
    v_mov_b32 v105, 0
    v_mov_b32 v106, 0
    v_mov_b32 v107, 0
    v_mov_b32 v108, 0
    v_mov_b32 v109, 0
    v_mov_b32 v110, 0
    v_mov_b32 v111, 0
    v_mov_b32 v112, 0
    v_mov_b32 v113, 0
    v_mov_b32 v114, 0
    v_mov_b32 v115, 0
    v_mov_b32 v116, 0
    v_mov_b32 v117, 0
    v_mov_b32 v118, 0
    v_mov_b32 v119, 0
    v_mov_b32 v120, 0
    v_mov_b32 v121, 0
    v_mov_b32 v122, 0
    v_mov_b32 v123, 0
    v_mov_b32 v124, 0
    v_mov_b32 v125, 0
    v_mov_b32 v126, 0
    v_mov_b32 v127, 0
    v_mov_b32 v128, 0
    v_mov_b32 v129, 0
    v_mov_b32 v130, 0
    v_mov_b32 v131, 0
    v_mov_b32 v132, 0
    v_mov_b32 v133, 0
    v_mov_b32 v134, 0
    v_mov_b32 v135, 0
    v_mov_b32 v136, 0
    v_mov_b32 v137, 0
    v_mov_b32 v138, 0
    v_mov_b32 v139, 0
    v_mov_b32 v140, 0
    v_mov_b32 v141, 0
    v_mov_b32 v142, 0
    v_mov_b32 v143, 0
    v_mov_b32 v144, 0
    v_mov_b32 v145, 0
    v_mov_b32 v146, 0
    v_mov_b32 v147, 0
    v_mov_b32 v148, 0
    v_mov_b32 v149, 0
    v_mov_b32 v150, 0
    v_mov_b32 v151, 0
    v_mov_b32 v152, 0
    v_mov_b32 v153, 0
    v_mov_b32 v154, 0
    v_mov_b32 v155, 0
    s_waitcnt lgkmcnt(0)
    s_load_dword s55, s[26:27], 0
    s_mov_b32 s28, s4
    s_and_b32 s29, s5, 0xffff
    s_mov_b32 s30, 0x280000
    s_mov_b32 s31, 0x20000
    v_mov_b32 v9, 0
    v_mov_b32 v220, 0
    v_mov_b32 v221, 0
    v_mov_b32 v222, 0
    v_mov_b32 v223, 0
    s_mov_b32 s25, 0
    s_mov_b32 s24, 0
    s_mov_b32 s15, 0
    s_mov_b32 s44, s26
    s_and_b32 s45, s27, 0xffff
    s_mov_b32 s46, 0x49000
    s_mov_b32 s47, 0x20000
    v_mov_b32 v8, 155648
    s_mov_b32 s60, -1
    s_mov_b32 s61, 0
    s_mov_b32 s94, 0
    s_mov_b32 s95, -1
    s_mov_b32 s62, 0xfffff
    s_mov_b32 s63, 0xfffff
    s_mov_b32 s96, -1
    s_mov_b32 s97, 0xff
    s_cmp_lg_u32 s52, 0
    s_cbranch_scc1 L_c1
    ds_write_b128 v8, v[92:95]
    ds_write_b128 v8, v[92:95] offset:16
    ds_write_b128 v8, v[92:95] offset:32
    ds_write_b128 v8, v[92:95] offset:48
L_c1:
    s_mov_b32 s36, s26
    s_and_b32 s37, s27, 0xffff
    s_mov_b32 s38, 0xdc8000
    s_mov_b32 s39, 0x20000
    v_and_b32 v2, 0, v1
    v_lshlrev_b32 v2, 20, v2
    buffer_load_dword v24, v2, s[36:39], 0 offen offset:512 sc1
    s_mov_b32 s40, 0x8000
    s_cmp_ge_u32 s54, 30
    s_cbranch_scc1 L_gate
    s_lshl_b32 s24, s99, 4
    s_add_u32 s24, s24, s98
    s_add_u32 s36, s26, 0x50000
    s_addc_u32 s37, s27, 0
    s_and_b32 s37, s37, 0xffff
    s_mov_b32 s38, 0x790000
    s_mov_b32 s39, 0x20000
    v_bfe_u32 v2, v1, 2, 2
    v_lshrrev_b32 v3, 5, v1
    v_lshl_add_u32 v3, v3, 3, v2
    v_lshlrev_b32 v3, 8, v3
    s_lshl_b32 s56, s101, 1
    v_xor_b32 v2, s56, v2
    v_lshl_add_u32 v3, v2, 6, v3
    v_bfe_u32 v2, v1, 4, 1
    v_lshl_add_u32 v3, v2, 5, v3
    v_add_u32 v3, 0x4000, v3
    v_and_b32 v6, 31, v1
    v_lshrrev_b32 v7, 5, v1
    s_cmp_ge_u32 s99, 10
    s_cbranch_scc1 L_v
    v_and_b32 v2, 1, v1
    v_lshl_add_u32 v3, v2, 4, v3
    v_bfe_u32 v2, v1, 1, 1
    v_lshl_add_u32 v14, v2, 3, v3
    v_xor_b32 v15, 64, v14
    s_cmp_ge_u32 s99, 5
    s_cselect_b32 s42, 1.0, 0x3ea52b5c
    s_mov_b32 s43, s42
    s_lshl_b32 s56, s99, 1
    s_add_u32 s56, s56, s101
    s_lshl_b32 s41, s56, 3
    s_mul_i32 s57, s41, 205
    s_lshr_b32 s57, s57, 10
    s_mul_i32 s57, s57, 5
    s_sub_u32 s41, s41, s57
    s_lshl_b32 s56, s56, 18
    s_lshl_b32 s57, s98, 1
    s_add_u32 s57, s57, s100
    s_lshl_b32 s57, s57, 10
    s_add_u32 s56, s56, s57
    v_lshlrev_b32 v220, 15, v7
    v_lshl_add_u32 v220, v6, 4, v220
    v_add_u32 v220, s56, v220
    v_add_u32 v221, 65536, v220
    v_add_u32 v222, 131072, v220
    v_add_u32 v223, 196608, v220
    s_waitcnt lgkmcnt(0)
    s_barrier
    ds_read_b128 v[28:31], v10 offset:0
    ds_read_b64_tr_b16 v[60:61], v14 offset:0
    ds_read_b64_tr_b16 v[62:63], v14 offset:1024
    ds_read_b128 v[32:35], v10 offset:4096
    ds_read_b64_tr_b16 v[64:65], v15 offset:0
    ds_read_b64_tr_b16 v[66:67], v15 offset:1024
    s_mov_b32 s58, 0
.p2align 5
L_qkloop:
    s_waitcnt lgkmcnt(3)
    v_mfma_f32_32x32x16_bf16 v[92:107], v[60:63], v[28:31], v[92:107]
    ds_read_b128 v[36:39], v11 offset:0
    ds_read_b64_tr_b16 v[68:69], v14 offset:4096
    ds_read_b64_tr_b16 v[70:71], v14 offset:5120
    s_waitcnt lgkmcnt(5)
    v_mfma_f32_32x32x16_bf16 v[124:139], v[60:63], v[32:35], v[124:139]
    ds_read_b128 v[40:43], v11 offset:4096
    s_waitcnt lgkmcnt(4)
    v_mfma_f32_32x32x16_bf16 v[108:123], v[64:67], v[28:31], v[108:123]
    ds_read_b64_tr_b16 v[72:73], v15 offset:4096
    ds_read_b64_tr_b16 v[74:75], v15 offset:5120
    v_mfma_f32_32x32x16_bf16 v[140:155], v[64:67], v[32:35], v[140:155]
    s_waitcnt lgkmcnt(3)
    v_mfma_f32_32x32x16_bf16 v[92:107], v[68:71], v[36:39], v[92:107]
    ds_read_b128 v[28:31], v12 offset:0
    ds_read_b64_tr_b16 v[60:61], v14 offset:8192
    ds_read_b64_tr_b16 v[62:63], v14 offset:9216
    s_waitcnt lgkmcnt(5)
    v_mfma_f32_32x32x16_bf16 v[124:139], v[68:71], v[40:43], v[124:139]
    ds_read_b128 v[32:35], v12 offset:4096
    s_waitcnt lgkmcnt(4)
    v_mfma_f32_32x32x16_bf16 v[108:123], v[72:75], v[36:39], v[108:123]
    ds_read_b64_tr_b16 v[64:65], v15 offset:8192
    ds_read_b64_tr_b16 v[66:67], v15 offset:9216
    v_mfma_f32_32x32x16_bf16 v[140:155], v[72:75], v[40:43], v[140:155]
    s_waitcnt lgkmcnt(3)
    v_mfma_f32_32x32x16_bf16 v[92:107], v[60:63], v[28:31], v[92:107]
    ds_read_b128 v[36:39], v13 offset:0
    ds_read_b64_tr_b16 v[68:69], v14 offset:12288
    ds_read_b64_tr_b16 v[70:71], v14 offset:13312
    s_waitcnt lgkmcnt(5)
    v_mfma_f32_32x32x16_bf16 v[124:139], v[60:63], v[32:35], v[124:139]
    ds_read_b128 v[40:43], v13 offset:4096
    s_waitcnt lgkmcnt(4)
    v_mfma_f32_32x32x16_bf16 v[108:123], v[64:67], v[28:31], v[108:123]
    ds_read_b64_tr_b16 v[72:73], v15 offset:12288
    ds_read_b64_tr_b16 v[74:75], v15 offset:13312
    v_mfma_f32_32x32x16_bf16 v[140:155], v[64:67], v[32:35], v[140:155]
    s_waitcnt lgkmcnt(0)
    v_mfma_f32_32x32x16_bf16 v[92:107], v[68:71], v[36:39], v[92:107]
    s_add_u32 s58, s58, 1
    s_barrier
    v_xor_b32 v10, s40, v10
    v_xor_b32 v11, s40, v11
    v_xor_b32 v12, s40, v12
    v_xor_b32 v13, s40, v13
    v_xor_b32 v14, s40, v14
    v_xor_b32 v15, s40, v15
    ds_read_b128 v[28:31], v10 offset:0
    ds_read_b64_tr_b16 v[60:61], v14 offset:0
    ds_read_b64_tr_b16 v[62:63], v14 offset:1024
    v_mfma_f32_32x32x16_bf16 v[124:139], v[68:71], v[40:43], v[124:139]
    ds_read_b128 v[32:35], v10 offset:4096
    v_mfma_f32_32x32x16_bf16 v[108:123], v[72:75], v[36:39], v[108:123]
    ds_read_b64_tr_b16 v[64:65], v15 offset:0
    ds_read_b64_tr_b16 v[66:67], v15 offset:1024
    s_xor_b32 s40, s40, 0x18000
    s_cmp_lg_u32 s58, 9
    v_mfma_f32_32x32x16_bf16 v[140:155], v[72:75], v[40:43], v[140:155]
    s_cbranch_scc1 L_qkloop
    ds_read_b128 v[36:39], v11 offset:0
    ds_read_b64_tr_b16 v[68:69], v14 offset:4096
    ds_read_b64_tr_b16 v[70:71], v14 offset:5120
    ds_read_b128 v[44:47], v12 offset:0
    ds_read_b64_tr_b16 v[76:77], v14 offset:8192
    ds_read_b64_tr_b16 v[78:79], v14 offset:9216
    ds_read_b128 v[52:55], v13 offset:0
    ds_read_b64_tr_b16 v[84:85], v14 offset:12288
    ds_read_b64_tr_b16 v[86:87], v14 offset:13312
    s_waitcnt lgkmcnt(12)
    v_mfma_f32_32x32x16_bf16 v[92:107], v[60:63], v[28:31], v[92:107]
    s_waitcnt lgkmcnt(6)
    v_mfma_f32_32x32x16_bf16 v[92:107], v[68:71], v[36:39], v[92:107]
    ds_read_b64_tr_b16 v[72:73], v15 offset:4096
    ds_read_b64_tr_b16 v[74:75], v15 offset:5120
    s_waitcnt lgkmcnt(5)
    v_mfma_f32_32x32x16_bf16 v[92:107], v[76:79], v[44:47], v[92:107]
    ds_read_b64_tr_b16 v[80:81], v15 offset:8192
    ds_read_b64_tr_b16 v[82:83], v15 offset:9216
    s_waitcnt lgkmcnt(4)
    v_mfma_f32_32x32x16_bf16 v[92:107], v[84:87], v[52:55], v[92:107]
    ds_read_b64_tr_b16 v[88:89], v15 offset:12288
    ds_read_b64_tr_b16 v[90:91], v15 offset:13312
    v_mfma_f32_32x32x16_bf16 v[108:123], v[64:67], v[28:31], v[108:123]
    s_waitcnt lgkmcnt(4)
    v_mfma_f32_32x32x16_bf16 v[108:123], v[72:75], v[36:39], v[108:123]
    ds_read_b128 v[40:43], v11 offset:4096
    s_waitcnt lgkmcnt(3)
    v_mfma_f32_32x32x16_bf16 v[108:123], v[80:83], v[44:47], v[108:123]
    ds_read_b128 v[48:51], v12 offset:4096
    s_waitcnt lgkmcnt(2)
    v_mfma_f32_32x32x16_bf16 v[108:123], v[88:91], v[52:55], v[108:123]
    ds_read_b128 v[56:59], v13 offset:4096
    v_mfma_f32_32x32x16_bf16 v[124:139], v[60:63], v[32:35], v[124:139]
    s_waitcnt lgkmcnt(0)
    v_mfma_f32_32x32x16_bf16 v[124:139], v[68:71], v[40:43], v[124:139]
    v_mov_b32 v2, 1
    s_mov_b64 exec, 1
    ds_add_u32 v8, v2 offset:8
    s_mov_b64 exec, -1
    v_mfma_f32_32x32x16_bf16 v[124:139], v[76:79], v[48:51], v[124:139]
    v_pk_mul_f32 v[92:93], v[92:93], s[42:43]
    v_pk_mul_f32 v[94:95], v[94:95], s[42:43]
    v_pk_mul_f32 v[96:97], v[96:97], s[42:43]
    v_pk_mul_f32 v[98:99], v[98:99], s[42:43]
    v_pk_mul_f32 v[100:101], v[100:101], s[42:43]
    v_pk_mul_f32 v[102:103], v[102:103], s[42:43]
    v_pk_mul_f32 v[104:105], v[104:105], s[42:43]
    v_pk_mul_f32 v[106:107], v[106:107], s[42:43]
    v_cvt_pk_bf16_f32 v224, v92, v93
    v_cvt_pk_bf16_f32 v225, v94, v95
    v_cvt_pk_bf16_f32 v226, v96, v97
    v_cvt_pk_bf16_f32 v227, v98, v99
    v_cvt_pk_bf16_f32 v228, v100, v101
    v_cvt_pk_bf16_f32 v229, v102, v103
    v_cvt_pk_bf16_f32 v230, v104, v105
    v_cvt_pk_bf16_f32 v231, v106, v107
    v_mfma_f32_32x32x16_bf16 v[124:139], v[84:87], v[56:59], v[124:139]
    v_mfma_f32_32x32x16_bf16 v[140:155], v[64:67], v[32:35], v[140:155]
    v_pk_mul_f32 v[108:109], v[108:109], s[42:43]
    v_pk_mul_f32 v[110:111], v[110:111], s[42:43]
    v_pk_mul_f32 v[112:113], v[112:113], s[42:43]
    v_pk_mul_f32 v[114:115], v[114:115], s[42:43]
    v_pk_mul_f32 v[116:117], v[116:117], s[42:43]
    v_pk_mul_f32 v[118:119], v[118:119], s[42:43]
    v_pk_mul_f32 v[120:121], v[120:121], s[42:43]
    v_pk_mul_f32 v[122:123], v[122:123], s[42:43]
    v_cvt_pk_bf16_f32 v232, v108, v109
    v_cvt_pk_bf16_f32 v233, v110, v111
    v_cvt_pk_bf16_f32 v234, v112, v113
    v_cvt_pk_bf16_f32 v235, v114, v115
    v_cvt_pk_bf16_f32 v236, v116, v117
    v_cvt_pk_bf16_f32 v237, v118, v119
    v_cvt_pk_bf16_f32 v238, v120, v121
    v_cvt_pk_bf16_f32 v239, v122, v123
    v_mfma_f32_32x32x16_bf16 v[140:155], v[72:75], v[40:43], v[140:155]
    v_mfma_f32_32x32x16_bf16 v[140:155], v[80:83], v[48:51], v[140:155]
    v_mfma_f32_32x32x16_bf16 v[140:155], v[88:91], v[56:59], v[140:155]
    v_pk_mul_f32 v[124:125], v[124:125], s[42:43]
    v_pk_mul_f32 v[126:127], v[126:127], s[42:43]
    v_pk_mul_f32 v[128:129], v[128:129], s[42:43]
    v_pk_mul_f32 v[130:131], v[130:131], s[42:43]
    v_pk_mul_f32 v[132:133], v[132:133], s[42:43]
    v_pk_mul_f32 v[134:135], v[134:135], s[42:43]
    v_pk_mul_f32 v[136:137], v[136:137], s[42:43]
    v_pk_mul_f32 v[138:139], v[138:139], s[42:43]
    v_cvt_pk_bf16_f32 v240, v124, v125
    v_cvt_pk_bf16_f32 v241, v126, v127
    v_cvt_pk_bf16_f32 v242, v128, v129
    v_cvt_pk_bf16_f32 v243, v130, v131
    v_cvt_pk_bf16_f32 v244, v132, v133
    v_cvt_pk_bf16_f32 v245, v134, v135
    v_cvt_pk_bf16_f32 v246, v136, v137
    v_cvt_pk_bf16_f32 v247, v138, v139
    s_cmp_eq_u32 s41, 2
    s_cselect_b32 exec_lo, -1, 0
    s_cmp_eq_u32 s41, 1
    s_cselect_b32 exec_hi, -1, 0
    v_swap_b32 v226, v240
    v_swap_b32 v227, v241
    s_cmp_eq_u32 s41, 0
    s_cselect_b32 exec_lo, -1, 0
    s_cmp_eq_u32 s41, 4
    s_cselect_b32 exec_hi, -1, 0
    v_swap_b32 v230, v244
    v_swap_b32 v231, v245
    s_mov_b64 exec, -1
    buffer_store_dwordx4 v[224:227], v220, s[36:39], 0 offen offset:0 sc1
    buffer_store_dwordx4 v[228:231], v221, s[36:39], 0 offen offset:0 sc1
    buffer_store_dwordx4 v[240:243], v220, s[36:39], 0 offen offset:512 sc1
    buffer_store_dwordx4 v[244:247], v221, s[36:39], 0 offen offset:512 sc1
    s_nop 1
    v_pk_mul_f32 v[140:141], v[140:141], s[42:43]
    v_pk_mul_f32 v[142:143], v[142:143], s[42:43]
    v_pk_mul_f32 v[144:145], v[144:145], s[42:43]
    v_pk_mul_f32 v[146:147], v[146:147], s[42:43]
    v_pk_mul_f32 v[148:149], v[148:149], s[42:43]
    v_pk_mul_f32 v[150:151], v[150:151], s[42:43]
    v_pk_mul_f32 v[152:153], v[152:153], s[42:43]
    v_pk_mul_f32 v[154:155], v[154:155], s[42:43]
    v_cvt_pk_bf16_f32 v248, v140, v141
    v_cvt_pk_bf16_f32 v249, v142, v143
    v_cvt_pk_bf16_f32 v250, v144, v145
    v_cvt_pk_bf16_f32 v251, v146, v147
    v_cvt_pk_bf16_f32 v252, v148, v149
    v_cvt_pk_bf16_f32 v253, v150, v151
    v_cvt_pk_bf16_f32 v254, v152, v153
    v_cvt_pk_bf16_f32 v255, v154, v155
    s_cmp_eq_u32 s41, 3
    s_cselect_b32 exec_lo, -1, 0
    s_cmp_eq_u32 s41, 2
    s_cselect_b32 exec_hi, -1, 0
    v_swap_b32 v234, v248
    v_swap_b32 v235, v249
    s_cmp_eq_u32 s41, 1
    s_cselect_b32 exec_lo, -1, 0
    s_cmp_eq_u32 s41, 0
    s_cselect_b32 exec_hi, -1, 0
    v_swap_b32 v238, v252
    v_swap_b32 v239, v253
    s_mov_b64 exec, -1
    buffer_store_dwordx4 v[232:235], v222, s[36:39], 0 offen offset:0 sc1
    buffer_store_dwordx4 v[236:239], v223, s[36:39], 0 offen offset:0 sc1
    buffer_store_dwordx4 v[248:251], v222, s[36:39], 0 offen offset:512 sc1
    buffer_store_dwordx4 v[252:255], v223, s[36:39], 0 offen offset:512 sc1
    s_branch L_adone
L_v:
    v_and_b32 v2, 3, v1
    v_lshl_add_u32 v14, v2, 3, v3
    v_xor_b32 v15, 64, v14
    s_lshl_b32 s56, s98, 1
    s_add_u32 s56, s56, s100
    s_mul_i32 s56, s56, 82944
    s_sub_u32 s57, s99, 10
    s_lshl_b32 s57, s57, 1
    s_add_u32 s57, s57, s101
    s_lshl_b32 s57, s57, 10
    s_add_u32 s56, s56, s57
    s_add_u32 s56, s56, 5275648
    v_mul_u32_u24 v220, 10368, v7
    v_lshl_add_u32 v220, v6, 4, v220
    v_add_u32 v220, s56, v220
    v_add_u32 v221, 20736, v220
    v_add_u32 v222, 41472, v220
    v_add_u32 v223, 62208, v220
    s_waitcnt lgkmcnt(0)
    s_barrier
    ds_read_b128 v[28:31], v10 offset:0
    ds_read_b64_tr_b16 v[60:61], v14 offset:0
    ds_read_b64_tr_b16 v[62:63], v14 offset:1024
    ds_read_b128 v[32:35], v10 offset:4096
    ds_read_b64_tr_b16 v[64:65], v15 offset:0
    ds_read_b64_tr_b16 v[66:67], v15 offset:1024
    s_mov_b32 s58, 0
.p2align 5
L_vloop:
    s_waitcnt lgkmcnt(3)
    v_mfma_f32_32x32x16_bf16 v[92:107], v[28:31], v[60:63], v[92:107]
    ds_read_b128 v[36:39], v11 offset:0
    ds_read_b64_tr_b16 v[68:69], v14 offset:4096
    ds_read_b64_tr_b16 v[70:71], v14 offset:5120
    s_waitcnt lgkmcnt(5)
    v_mfma_f32_32x32x16_bf16 v[124:139], v[32:35], v[60:63], v[124:139]
    ds_read_b128 v[40:43], v11 offset:4096
    s_waitcnt lgkmcnt(4)
    v_mfma_f32_32x32x16_bf16 v[108:123], v[28:31], v[64:67], v[108:123]
    ds_read_b64_tr_b16 v[72:73], v15 offset:4096
    ds_read_b64_tr_b16 v[74:75], v15 offset:5120
    v_mfma_f32_32x32x16_bf16 v[140:155], v[32:35], v[64:67], v[140:155]
    s_waitcnt lgkmcnt(3)
    v_mfma_f32_32x32x16_bf16 v[92:107], v[36:39], v[68:71], v[92:107]
    ds_read_b128 v[28:31], v12 offset:0
    ds_read_b64_tr_b16 v[60:61], v14 offset:8192
    ds_read_b64_tr_b16 v[62:63], v14 offset:9216
    s_waitcnt lgkmcnt(5)
    v_mfma_f32_32x32x16_bf16 v[124:139], v[40:43], v[68:71], v[124:139]
    ds_read_b128 v[32:35], v12 offset:4096
    s_waitcnt lgkmcnt(4)
    v_mfma_f32_32x32x16_bf16 v[108:123], v[36:39], v[72:75], v[108:123]
    ds_read_b64_tr_b16 v[64:65], v15 offset:8192
    ds_read_b64_tr_b16 v[66:67], v15 offset:9216
    v_mfma_f32_32x32x16_bf16 v[140:155], v[40:43], v[72:75], v[140:155]
    s_waitcnt lgkmcnt(3)
    v_mfma_f32_32x32x16_bf16 v[92:107], v[28:31], v[60:63], v[92:107]
    ds_read_b128 v[36:39], v13 offset:0
    ds_read_b64_tr_b16 v[68:69], v14 offset:12288
    ds_read_b64_tr_b16 v[70:71], v14 offset:13312
    s_waitcnt lgkmcnt(5)
    v_mfma_f32_32x32x16_bf16 v[124:139], v[32:35], v[60:63], v[124:139]
    ds_read_b128 v[40:43], v13 offset:4096
    s_waitcnt lgkmcnt(4)
    v_mfma_f32_32x32x16_bf16 v[108:123], v[28:31], v[64:67], v[108:123]
    ds_read_b64_tr_b16 v[72:73], v15 offset:12288
    ds_read_b64_tr_b16 v[74:75], v15 offset:13312
    v_mfma_f32_32x32x16_bf16 v[140:155], v[32:35], v[64:67], v[140:155]
    s_waitcnt lgkmcnt(0)
    v_mfma_f32_32x32x16_bf16 v[92:107], v[36:39], v[68:71], v[92:107]
    s_add_u32 s58, s58, 1
    s_barrier
    v_xor_b32 v10, s40, v10
    v_xor_b32 v11, s40, v11
    v_xor_b32 v12, s40, v12
    v_xor_b32 v13, s40, v13
    v_xor_b32 v14, s40, v14
    v_xor_b32 v15, s40, v15
    ds_read_b128 v[28:31], v10 offset:0
    ds_read_b64_tr_b16 v[60:61], v14 offset:0
    ds_read_b64_tr_b16 v[62:63], v14 offset:1024
    v_mfma_f32_32x32x16_bf16 v[124:139], v[40:43], v[68:71], v[124:139]
    ds_read_b128 v[32:35], v10 offset:4096
    v_mfma_f32_32x32x16_bf16 v[108:123], v[36:39], v[72:75], v[108:123]
    ds_read_b64_tr_b16 v[64:65], v15 offset:0
    ds_read_b64_tr_b16 v[66:67], v15 offset:1024
    s_xor_b32 s40, s40, 0x18000
    s_cmp_lg_u32 s58, 9
    v_mfma_f32_32x32x16_bf16 v[140:155], v[40:43], v[72:75], v[140:155]
    s_cbranch_scc1 L_vloop
    ds_read_b128 v[36:39], v11 offset:0
    ds_read_b64_tr_b16 v[68:69], v14 offset:4096
    ds_read_b64_tr_b16 v[70:71], v14 offset:5120
    ds_read_b128 v[44:47], v12 offset:0
    ds_read_b64_tr_b16 v[76:77], v14 offset:8192
    ds_read_b64_tr_b16 v[78:79], v14 offset:9216
    ds_read_b128 v[52:55], v13 offset:0
    ds_read_b64_tr_b16 v[84:85], v14 offset:12288
    ds_read_b64_tr_b16 v[86:87], v14 offset:13312
    s_waitcnt lgkmcnt(12)
    v_mfma_f32_32x32x16_bf16 v[92:107], v[28:31], v[60:63], v[92:107]
    s_waitcnt lgkmcnt(6)
    v_mfma_f32_32x32x16_bf16 v[92:107], v[36:39], v[68:71], v[92:107]
    ds_read_b64_tr_b16 v[72:73], v15 offset:4096
    ds_read_b64_tr_b16 v[74:75], v15 offset:5120
    s_waitcnt lgkmcnt(5)
    v_mfma_f32_32x32x16_bf16 v[92:107], v[44:47], v[76:79], v[92:107]
    ds_read_b64_tr_b16 v[80:81], v15 offset:8192
    ds_read_b64_tr_b16 v[82:83], v15 offset:9216
    s_waitcnt lgkmcnt(4)
    v_mfma_f32_32x32x16_bf16 v[92:107], v[52:55], v[84:87], v[92:107]
    ds_read_b64_tr_b16 v[88:89], v15 offset:12288
    ds_read_b64_tr_b16 v[90:91], v15 offset:13312
    v_mfma_f32_32x32x16_bf16 v[108:123], v[28:31], v[64:67], v[108:123]
    s_waitcnt lgkmcnt(4)
    v_mfma_f32_32x32x16_bf16 v[108:123], v[36:39], v[72:75], v[108:123]
    ds_read_b128 v[40:43], v11 offset:4096
    s_waitcnt lgkmcnt(3)
    v_mfma_f32_32x32x16_bf16 v[108:123], v[44:47], v[80:83], v[108:123]
    ds_read_b128 v[48:51], v12 offset:4096
    s_waitcnt lgkmcnt(2)
    v_mfma_f32_32x32x16_bf16 v[108:123], v[52:55], v[88:91], v[108:123]
    ds_read_b128 v[56:59], v13 offset:4096
    v_mfma_f32_32x32x16_bf16 v[124:139], v[32:35], v[60:63], v[124:139]
    s_waitcnt lgkmcnt(0)
    v_mfma_f32_32x32x16_bf16 v[124:139], v[40:43], v[68:71], v[124:139]
    v_mov_b32 v2, 1
    s_mov_b64 exec, 1
    ds_add_u32 v8, v2 offset:8
    s_mov_b64 exec, -1
    v_mfma_f32_32x32x16_bf16 v[124:139], v[48:51], v[76:79], v[124:139]
    v_cvt_pk_bf16_f32 v224, v92, v93
    v_cvt_pk_bf16_f32 v225, v94, v95
    v_cvt_pk_bf16_f32 v226, v96, v97
    v_cvt_pk_bf16_f32 v227, v98, v99
    v_cvt_pk_bf16_f32 v228, v100, v101
    v_cvt_pk_bf16_f32 v229, v102, v103
    v_cvt_pk_bf16_f32 v230, v104, v105
    v_cvt_pk_bf16_f32 v231, v106, v107
    buffer_store_dwordx4 v[224:227], v220, s[36:39], 0 offen offset:0 sc1
    buffer_store_dwordx4 v[228:231], v221, s[36:39], 0 offen offset:0 sc1
    v_mfma_f32_32x32x16_bf16 v[124:139], v[56:59], v[84:87], v[124:139]
    v_mfma_f32_32x32x16_bf16 v[140:155], v[32:35], v[64:67], v[140:155]
    v_cvt_pk_bf16_f32 v240, v108, v109
    v_cvt_pk_bf16_f32 v241, v110, v111
    v_cvt_pk_bf16_f32 v242, v112, v113
    v_cvt_pk_bf16_f32 v243, v114, v115
    v_cvt_pk_bf16_f32 v244, v116, v117
    v_cvt_pk_bf16_f32 v245, v118, v119
    v_cvt_pk_bf16_f32 v246, v120, v121
    v_cvt_pk_bf16_f32 v247, v122, v123
    buffer_store_dwordx4 v[240:243], v220, s[36:39], 0 offen offset:512 sc1
    buffer_store_dwordx4 v[244:247], v221, s[36:39], 0 offen offset:512 sc1
    v_mfma_f32_32x32x16_bf16 v[140:155], v[40:43], v[72:75], v[140:155]
    v_mfma_f32_32x32x16_bf16 v[140:155], v[48:51], v[80:83], v[140:155]
    v_mfma_f32_32x32x16_bf16 v[140:155], v[56:59], v[88:91], v[140:155]
    v_cvt_pk_bf16_f32 v232, v124, v125
    v_cvt_pk_bf16_f32 v233, v126, v127
    v_cvt_pk_bf16_f32 v234, v128, v129
    v_cvt_pk_bf16_f32 v235, v130, v131
    v_cvt_pk_bf16_f32 v236, v132, v133
    v_cvt_pk_bf16_f32 v237, v134, v135
    v_cvt_pk_bf16_f32 v238, v136, v137
    v_cvt_pk_bf16_f32 v239, v138, v139
    buffer_store_dwordx4 v[232:235], v222, s[36:39], 0 offen offset:0 sc1
    buffer_store_dwordx4 v[236:239], v223, s[36:39], 0 offen offset:0 sc1
    s_nop 1
    v_cvt_pk_bf16_f32 v248, v140, v141
    v_cvt_pk_bf16_f32 v249, v142, v143
    v_cvt_pk_bf16_f32 v250, v144, v145
    v_cvt_pk_bf16_f32 v251, v146, v147
    v_cvt_pk_bf16_f32 v252, v148, v149
    v_cvt_pk_bf16_f32 v253, v150, v151
    v_cvt_pk_bf16_f32 v254, v152, v153
    v_cvt_pk_bf16_f32 v255, v154, v155
    buffer_store_dwordx4 v[248:251], v222, s[36:39], 0 offen offset:512 sc1
    buffer_store_dwordx4 v[252:255], v223, s[36:39], 0 offen offset:512 sc1
    s_branch L_adone
L_gate:
    s_mov_b32 s24, s2
    s_waitcnt lgkmcnt(0)
    s_barrier
    s_add_u32 s36, s26, 0xa80000
    s_addc_u32 s37, s27, 0
    s_and_b32 s37, s37, 0xffff
    s_mov_b32 s38, 0x280000
    s_mov_b32 s39, 0x20000
    s_sub_u32 s56, s2, 240
    s_lshl_b32 s56, s56, 2
    s_add_u32 s56, s56, s52
    s_mul_i32 s56, s56, 40960
    s_add_u32 s57, s56, 40960
    v_lshlrev_b32 v5, 4, v1
    v_mov_b32 v228, -1
    v_mov_b32 v229, -1
    v_mov_b32 v230, -1
    v_mov_b32 v231, -1
L_spl:
    buffer_store_dwordx4 v[228:231], v5, s[36:39], s56 offen offset:0 sc1
    buffer_store_dwordx4 v[228:231], v5, s[36:39], s56 offen offset:1024 sc1
    buffer_store_dwordx4 v[228:231], v5, s[36:39], s56 offen offset:2048 sc1
    buffer_store_dwordx4 v[228:231], v5, s[36:39], s56 offen offset:3072 sc1
    s_add_u32 s56, s56, 4096
    s_cmp_lt_u32 s56, s57
    s_cbranch_scc1 L_spl
    v_mov_b32 v2, 1
    s_mov_b64 exec, 1
    ds_add_u32 v8, v2 offset:8
    s_mov_b64 exec, -1
L_adone:
    v_mov_b32 v2, 1
    s_mov_b64 exec, 1
    ds_add_u32 v8, v2 offset:20
    s_mov_b64 exec, -1
    s_add_u32 s55, s55, 1
    s_lshl_b32 s24, s24, 7
    s_add_u32 s24, s24, 4096
    s_and_b32 s56, s54, 3
    s_lshl_b32 s98, s53, 2
    s_add_u32 s98, s98, s56
    s_lshr_b32 s99, s54, 2
    s_lshr_b32 s100, s52, 1
    s_and_b32 s48, s98, 1
    s_lshr_b32 s50, s98, 1
    s_mul_i32 s50, s50, 163840
    v_and_b32 v2, 31, v1
    v_lshrrev_b32 v3, 5, v1
    v_and_b32 v4, 0x13, v2
    v_bfe_u32 v5, v2, 2, 1
    v_lshl_add_u32 v4, v5, 3, v4
    v_bfe_u32 v5, v2, 3, 1
    v_lshl_add_u32 v4, v5, 2, v4
    s_mul_i32 s56, s48, 98304
    v_lshlrev_b32 v10, 15, v3
    v_lshl_add_u32 v10, v4, 4, v10
    v_add_u32 v10, s56, v10
    s_lshl_b32 s56, s48, 9
    s_add_u32 s56, s56, 65536
    v_lshl_add_u32 v11, v4, 4, s56
    s_sub_u32 s56, 2621440, s50
    s_mov_b64 exec, s[94:95]
    v_mov_b32 v11, s56
    s_mov_b64 exec, -1
    v_mov_b32 v12, 0xdddddddd
    s_lshl_b32 s56, s48, 2
    v_add_u32 v4, s56, v4
    v_subrev_u32 v5, 20, v4
    v_min_u32 v4, v4, v5
    s_mul_i32 s56, s98, 320
    v_mul_u32_u24 v14, 10368, v3
    v_lshl_add_u32 v14, v4, 4, v14
    v_add_u32 v14, s56, v14
    s_mov_b32 exec_lo, 0x100000
    s_mov_b32 exec_hi, 0x100000
    v_mul_u32_u24 v14, 10368, v3
    v_add_u32 v14, 10240, v14
    s_mov_b32 exec_lo, 0xffe00000
    s_mov_b32 exec_hi, 0xffe00000
    v_mov_b32 v14, 0x40000000
    s_mov_b64 exec, -1
    v_add_u32 v15, 20736, v14
    v_add_u32 v16, 41472, v14
    v_add_u32 v17, 62208, v14
    v_add_u32 v18, 82944, v14
    v_add_u32 v19, 103680, v14
    v_add_u32 v20, 124416, v14
    v_add_u32 v21, 145152, v14
    s_add_u32 s56, s50, 2949120
    s_add_u32 s28, s26, s56
    s_addc_u32 s29, s27, 0
    s_and_b32 s29, s29, 0xffff
    s_mov_b32 s30, 0x288000
    s_mov_b32 s31, 0x20000
    s_mul_i32 s56, s100, 1327104
    s_add_u32 s56, s56, 5603328
    s_add_u32 s32, s26, s56
    s_addc_u32 s33, s27, 0
    s_and_b32 s33, s33, 0xffff
    s_mov_b32 s34, 0x144000
    s_mov_b32 s35, 0x20000
    s_add_u32 s56, s50, 327680
    s_add_u32 s36, s26, s56
    s_addc_u32 s37, s27, 0
    s_and_b32 s37, s37, 0xffff
    s_mov_b32 s38, 0x28000
    s_mov_b32 s39, 0x20000
    s_lshl_b32 s101, s100, 14
    s_mul_i32 s14, s100, 1327104
    s_lshl_b32 s51, s99, 1
    s_and_b32 s56, s52, 1
    s_add_u32 s51, s51, s56
    s_lshl_b32 s51, s51, 1
    s_add_u32 s51, s51, s100
    s_lshl_b32 s51, s51, 10
    v_mov_b64 v[40:41], 0
    v_mov_b64 v[42:43], 0
    v_mov_b64 v[44:45], 0
    v_mov_b64 v[46:47], 0
    v_mov_b64 v[100:101], 0
    v_mov_b64 v[102:103], 0
    s_mul_i32 s56, s98, 20
    v_bfe_u32 v2, v1, 4, 1
    v_mul_u32_u24 v2, 19, v2
    v_add_u32 v2, s56, v2
    v_lshrrev_b32 v2, 7, v2
    v_lshrrev_b32 v3, 5, v1
    v_mul_u32_u24 v3, 5, v3
    v_add3_u32 v3, v3, v2, 5
    v_and_b32 v4, 15, v1
    v_lshl_add_u32 v3, v3, 4, v4
    v_lshlrev_b32 v104, 7, v3
    v_and_b32 v104, 0xfffffcff, v104
    s_lshl_b32 s56, s99, 1
    v_and_b32 v4, 1, v1
    v_lshl_add_u32 v2, v2, 4, v4
    v_add_u32 v2, s56, v2
    s_mov_b64 exec, s[94:95]
    v_mov_b32 v2, 256
    s_mov_b64 exec, -1
    v_lshlrev_b32 v105, 7, v2
    v_mov_b32 v2, 1
    s_waitcnt vmcnt(0)
    s_mov_b64 exec, 1
    ds_add_rtn_u32 v3, v8, v2 offset:4
    s_mov_b64 exec, -1
    s_waitcnt lgkmcnt(0)
    v_readfirstlane_b32 s56, v3
    s_nop 1
    s_cmp_lg_u32 s56, 3
    s_cbranch_scc1 L_nsig
    v_mov_b32 v2, 0
    v_mov_b32 v3, s55
    s_mov_b64 exec, 1
    buffer_store_dword v3, v2, s[44:47], s24 offen sc1
    s_mov_b64 exec, -1
L_nsig:
    v_mov_b64 v[168:169], 0
    v_mov_b64 v[170:171], 0
    v_mov_b64 v[172:173], 0
    v_mov_b64 v[174:175], 0
    v_mov_b64 v[176:177], 0
    v_mov_b64 v[178:179], 0
    v_mov_b64 v[180:181], 0
    v_mov_b64 v[182:183], 0
    v_mov_b64 v[184:185], 0
    v_mov_b64 v[186:187], 0
    v_mov_b64 v[188:189], 0
    v_mov_b64 v[190:191], 0
    v_mov_b64 v[192:193], 0
    v_mov_b64 v[194:195], 0
    v_mov_b64 v[196:197], 0
    v_mov_b64 v[198:199], 0
    v_mov_b64 v[200:201], 0
    v_mov_b64 v[202:203], 0
    v_mov_b64 v[204:205], 0
    v_mov_b64 v[206:207], 0
    v_mov_b64 v[208:209], 0
    v_mov_b64 v[210:211], 0
    v_mov_b64 v[212:213], 0
    v_mov_b64 v[214:215], 0
    v_mov_b64 v[216:217], 0
    v_mov_b64 v[218:219], 0
    v_mov_b64 v[220:221], 0
    v_mov_b64 v[222:223], 0
    v_mov_b64 v[224:225], 0
    v_mov_b64 v[226:227], 0
    v_mov_b64 v[228:229], 0
    v_mov_b64 v[230:231], 0
    v_and_b32 v2, 15, v1
    v_lshrrev_b32 v3, 4, v1
    v_and_b32 v6, 0x13, v2
    v_bfe_u32 v5, v2, 2, 1
    v_lshl_add_u32 v6, v5, 3, v6
    v_bfe_u32 v5, v2, 3, 1
    v_lshl_add_u32 v6, v5, 2, v6
    s_and_b32 s56, s52, 3
    s_lshl_b32 s56, s56, 4
    s_lshl_b32 s57, s98, 6
    s_add_u32 s56, s56, s57
    v_add_u32 v4, s56, v2
    s_and_b32 s56, s52, 1
    s_lshl_b32 s56, s56, 10
    s_and_b32 s57, s52, 2
    s_lshl_b32 s57, s57, 4
    s_add_u32 s56, s56, s57
    s_add_u32 s56, s56, s98
    v_lshl_add_u32 v2, v6, 6, s56
    v_lshlrev_b32 v238, 4, v4
    v_lshl_add_u32 v238, v3, 15, v238
    v_add_u32 v238, 1572864, v238
    v_mul_u32_u24 v239, 1280, v2
    v_lshl_add_u32 v239, v3, 3, v239
    s_mul_i32 s56, s99, 160
    v_add_u32 v239, s56, v239
    v_lshrrev_b32 v4, 2, v1
    v_and_b32 v3, 3, v1
    v_mul_u32_u24 v242, 160, v4
    v_lshl_add_u32 v242, v3, 3, v242
    v_add_u32 v242, 61440, v242
    s_and_b32 s56, s52, 3
    s_mul_i32 s56, s56, 6144
    s_add_u32 s56, s56, 131072
    v_lshl_add_u32 v240, v1, 4, s56
    s_and_b32 s56, s52, 3
    s_xor_b32 s56, s56, 2
    s_mul_i32 s56, s56, 6144
    s_add_u32 s56, s56, 131072
    v_lshl_add_u32 v241, v1, 4, s56
    s_add_u32 s40, s26, 0xa80000
    s_addc_u32 s41, s27, 0
    s_and_b32 s41, s41, 0xffff
    s_mov_b32 s42, 0x280000
    s_mov_b32 s43, 0x20000
    s_lshl_b32 s56, s52, 2
    v_add_u32 v245, s56, v8
    v_xor_b32 v246, 8, v245
    v_mov_b32 v247, 1
    v_and_b32 v248, 0x1f0, v10
    s_and_b32 s56, s98, 1
    s_lshl_b32 s56, s56, 3
    s_add_u32 s56, s56, 65536
    v_add_u32 v248, s56, v248
    s_cmp_eq_u32 s52, 0
    s_cbranch_scc1 L_poll
    s_mov_b32 s59, 1600000
L_wa:
    ds_read_b32 v2, v8 offset:0
    s_waitcnt lgkmcnt(0)
    v_readfirstlane_b32 s56, v2
    s_nop 1
    s_cmp_eq_u32 s56, 1
    s_cbranch_scc0 L_was
L_wad:
    s_branch L_go
L_poll:
    s_mov_b32 s57, 4096
    s_mov_b32 s59, 200000
L_pa:
    buffer_load_dword v4, v104, s[44:47], s57 offen sc1
    buffer_load_dword v5, v105, s[44:47], s57 offen sc1
    s_waitcnt vmcnt(0)
    v_xor_b32 v4, s55, v4
    v_xor_b32 v5, s55, v5
    v_or_b32 v4, v4, v5
    v_cmp_ne_u32 vcc, 0, v4
    s_nop 1
    s_cmp_eq_u64 vcc, 0
    s_cbranch_scc0 L_pas
L_pad:
    v_mov_b32 v2, 1
    ds_write_b32 v8, v2 offset:0
L_go:
    s_setprio 3
    buffer_load_dwordx4 v[232:235], v10, s[28:31], 0 offen
    s_xor_b32 s57, s51, 1024
    buffer_load_dwordx4 v[24:27], v10, s[36:39], s57 offen offset:0
    buffer_load_dwordx4 v[28:31], v10, s[36:39], s57 offen offset:512
    buffer_load_dwordx4 v[32:35], v10, s[36:39], s51 offen offset:0
    buffer_load_dwordx4 v[36:39], v10, s[36:39], s51 offen offset:512
    s_mov_b64 exec, s[60:61]
    buffer_load_dwordx4 v[40:43], v11, s[36:39], s57 offen
    buffer_load_dwordx4 v[44:47], v11, s[36:39], s51 offen
    s_mov_b64 exec, -1
    buffer_load_dwordx2 v[236:237], v11, s[28:31], 0 offen
    s_add_u32 s28, s28, s101
    s_addc_u32 s29, s29, 0
    buffer_load_dwordx4 v[64:67], v11, s[28:31], 0 offen offset:0
    buffer_load_dwordx4 v[48:51], v10, s[28:31], 0 offen offset:0
    buffer_load_dwordx4 v[72:75], v14, s[32:35], 0 offen
    buffer_load_dwordx4 v[76:79], v15, s[32:35], 0 offen
    buffer_load_dwordx4 v[52:55], v10, s[28:31], 0 offen offset:512
    buffer_load_dwordx4 v[80:83], v16, s[32:35], 0 offen
    buffer_load_dwordx4 v[84:87], v17, s[32:35], 0 offen
    buffer_load_dwordx4 v[56:59], v10, s[28:31], 0 offen offset:1024
    buffer_load_dwordx4 v[88:91], v18, s[32:35], 0 offen
    buffer_load_dwordx4 v[92:95], v19, s[32:35], 0 offen
    buffer_load_dwordx4 v[60:63], v10, s[28:31], 0 offen offset:1536
    buffer_load_dwordx4 v[68:71], v11, s[28:31], 0 offen offset:1024
    v_mov_b32 v2, 1
    s_mov_b64 exec, 1
    ds_add_u32 v8, v2 offset:56
    s_mov_b64 exec, -1
    s_add_u32 s56, s50, 11010048
    s_add_u32 s36, s26, s56
    s_addc_u32 s37, s27, 0
    s_and_b32 s37, s37, 0xffff
    s_mov_b32 s38, 0x28000
    s_mov_b32 s39, 0x20000
    s_waitcnt vmcnt(12)
    v_mfma_f32_32x32x16_bf16 v[104:119], v[232:235], v[24:27], 0
    v_mfma_f32_32x32x16_bf16 v[120:135], v[232:235], v[28:31], 0
    v_mfma_f32_32x32x16_bf16 v[136:151], v[232:235], v[32:35], 0
    v_mfma_f32_32x32x16_bf16 v[152:167], v[232:235], v[36:39], 0
    v_mfma_f32_32x32x8_bf16 v[104:119], v[236:237], v[40:41], v[104:119]
    v_mfma_f32_32x32x8_bf16 v[120:135], v[236:237], v[42:43], v[120:135]
    v_mfma_f32_32x32x8_bf16 v[136:151], v[236:237], v[44:45], v[136:151]
    v_mfma_f32_32x32x8_bf16 v[152:167], v[236:237], v[46:47], v[152:167]
    s_nop 8
    s_mov_b64 exec, s[94:95]
    v_max3_f32 v104, v104, v105, v106
    v_max3_f32 v104, v104, v107, v108
    v_max3_f32 v104, v104, v109, v110
    v_max3_f32 v104, v104, v111, v112
    v_max3_f32 v104, v104, v113, v114
    v_max3_f32 v104, v104, v115, v116
    v_max3_f32 v104, v104, v117, v118
    v_max_f32 v104, v104, v119
    v_cvt_pk_bf16_f32 v40, -v104, 0
    s_mov_b64 exec, -1
    s_waitcnt vmcnt(7)
    v_mfma_f32_32x32x16_bf16 v[104:119], v[48:51], v[24:27], 0
    s_mov_b64 exec, s[94:95]
    v_max3_f32 v120, v120, v121, v122
    v_max3_f32 v120, v120, v123, v124
    v_max3_f32 v120, v120, v125, v126
    v_max3_f32 v120, v120, v127, v128
    v_max3_f32 v120, v120, v129, v130
    v_max3_f32 v120, v120, v131, v132
    v_max3_f32 v120, v120, v133, v134
    v_max_f32 v120, v120, v135
    v_cvt_pk_bf16_f32 v42, -v120, 0
    s_mov_b64 exec, -1
    v_mfma_f32_32x32x8_bf16 v[104:119], v[64:65], v[40:41], v[104:119]
    v_mfma_f32_32x32x16_bf16 v[120:135], v[48:51], v[28:31], 0
    s_mov_b64 exec, s[94:95]
    v_max3_f32 v136, v136, v137, v138
    v_max3_f32 v136, v136, v139, v140
    v_max3_f32 v136, v136, v141, v142
    v_max3_f32 v136, v136, v143, v144
    v_max3_f32 v136, v136, v145, v146
    v_max3_f32 v136, v136, v147, v148
    v_max3_f32 v136, v136, v149, v150
    v_max_f32 v136, v136, v151
    v_cvt_pk_bf16_f32 v44, -v136, 0
    v_max3_f32 v152, v152, v153, v154
    v_max3_f32 v152, v152, v155, v156
    v_max3_f32 v152, v152, v157, v158
    v_max3_f32 v152, v152, v159, v160
    v_max3_f32 v152, v152, v161, v162
    v_max3_f32 v152, v152, v163, v164
    v_max3_f32 v152, v152, v165, v166
    v_max_f32 v152, v152, v167
    v_cvt_pk_bf16_f32 v46, -v152, 0
    s_mov_b64 exec, -1
    v_mov_b64 v[160:161], 0
    v_mov_b64 v[162:163], 0
    v_mov_b64 v[164:165], 0
    v_mov_b64 v[166:167], 0
    s_mov_b32 s58, 0
    s_branch L_in
.p2align 6
L_loop:
    v_exp_f32 v132, v132
    v_exp_f32 v133, v133
    v_exp_f32 v134, v134
    v_exp_f32 v135, v135
    v_mfma_f32_32x32x8_bf16 v[152:167], v[70:71], v[46:47], v[152:167]
    v_exp_f32 v136, v136
    v_exp_f32 v137, v137
    v_exp_f32 v138, v138
    v_exp_f32 v139, v139
    v_smfmac_f32_32x32x32_bf16 v[184:199], v[100:103], v[128:135], v12
    buffer_load_dwordx4 v[60:63], v10, s[28:31], 0 offen offset:3584
    buffer_load_dwordx4 v[68:71], v11, s[28:31], 0 offen offset:3072
    v_exp_f32 v140, v140
    v_exp_f32 v141, v141
    v_exp_f32 v142, v142
    v_exp_f32 v143, v143
    v_mfma_f32_32x32x16_bf16 v[104:119], v[48:51], v[24:27], 0
    v_exp_f32 v144, v144
    v_exp_f32 v145, v145
    v_exp_f32 v146, v146
    v_exp_f32 v147, v147
    v_smfmac_f32_32x32x32_bf16 v[200:215], v[96:99], v[136:143], v12
    s_waitcnt vmcnt(7)
    v_exp_f32 v148, v148
    v_exp_f32 v149, v149
    v_exp_f32 v150, v150
    v_exp_f32 v151, v151
    v_mfma_f32_32x32x8_bf16 v[104:119], v[64:65], v[40:41], v[104:119]
    v_exp_f32 v152, v152
    v_exp_f32 v153, v153
    v_exp_f32 v154, v154
    v_exp_f32 v155, v155
    v_smfmac_f32_32x32x32_bf16 v[200:215], v[100:103], v[144:151], v12
    v_exp_f32 v156, v156
    v_exp_f32 v157, v157
    v_exp_f32 v158, v158
    v_exp_f32 v159, v159
    v_mfma_f32_32x32x16_bf16 v[120:135], v[48:51], v[28:31], 0
    v_exp_f32 v160, v160
    v_exp_f32 v161, v161
    v_exp_f32 v162, v162
    v_exp_f32 v163, v163
    v_smfmac_f32_32x32x32_bf16 v[216:231], v[96:99], v[152:159], v12
    s_add_u32 s28, s28, 2048
    s_addc_u32 s29, s29, 0
    v_exp_f32 v164, v164
    v_exp_f32 v165, v165
    v_exp_f32 v166, v166
    v_exp_f32 v167, v167
L_in:
    v_mfma_f32_32x32x8_bf16 v[120:135], v[64:65], v[42:43], v[120:135]
    v_exp_f32 v104, v104
    v_exp_f32 v105, v105
    v_exp_f32 v106, v106
    v_exp_f32 v107, v107
    v_smfmac_f32_32x32x32_bf16 v[216:231], v[100:103], v[160:167], v12
    buffer_load_dwordx4 v[96:99], v20, s[32:35], 0 offen
    buffer_load_dwordx4 v[100:103], v21, s[32:35], 0 offen
    v_exp_f32 v108, v108
    v_exp_f32 v109, v109
    v_exp_f32 v110, v110
    v_exp_f32 v111, v111
    v_mfma_f32_32x32x16_bf16 v[136:151], v[48:51], v[32:35], 0
    v_exp_f32 v112, v112
    v_exp_f32 v113, v113
    v_exp_f32 v114, v114
    v_exp_f32 v115, v115
    v_smfmac_f32_32x32x32_bf16 v[168:183], v[72:75], v[104:111], v12
    v_exp_f32 v116, v116
    v_exp_f32 v117, v117
    v_exp_f32 v118, v118
    v_exp_f32 v119, v119
    v_mfma_f32_32x32x8_bf16 v[136:151], v[64:65], v[44:45], v[136:151]
    v_exp_f32 v120, v120
    v_exp_f32 v121, v121
    v_exp_f32 v122, v122
    v_exp_f32 v123, v123
    v_smfmac_f32_32x32x32_bf16 v[168:183], v[76:79], v[112:119], v12
    v_exp_f32 v124, v124
    v_exp_f32 v125, v125
    v_exp_f32 v126, v126
    v_exp_f32 v127, v127
    v_mfma_f32_32x32x16_bf16 v[152:167], v[48:51], v[36:39], 0
    v_exp_f32 v128, v128
    v_exp_f32 v129, v129
    v_exp_f32 v130, v130
    v_exp_f32 v131, v131
    v_smfmac_f32_32x32x32_bf16 v[184:199], v[72:75], v[120:127], v12
    v_exp_f32 v132, v132
    v_exp_f32 v133, v133
    v_exp_f32 v134, v134
    v_exp_f32 v135, v135
    v_mfma_f32_32x32x8_bf16 v[152:167], v[64:65], v[46:47], v[152:167]
    v_exp_f32 v136, v136
    v_exp_f32 v137, v137
    v_exp_f32 v138, v138
    v_exp_f32 v139, v139
    v_smfmac_f32_32x32x32_bf16 v[184:199], v[76:79], v[128:135], v12
    buffer_load_dwordx4 v[48:51], v10, s[28:31], 0 offen offset:2048
    v_exp_f32 v140, v140
    v_exp_f32 v141, v141
    v_exp_f32 v142, v142
    v_exp_f32 v143, v143
    v_mfma_f32_32x32x16_bf16 v[104:119], v[52:55], v[24:27], 0
    v_exp_f32 v144, v144
    v_exp_f32 v145, v145
    v_exp_f32 v146, v146
    v_exp_f32 v147, v147
    v_smfmac_f32_32x32x32_bf16 v[200:215], v[72:75], v[136:143], v12
    s_waitcnt vmcnt(7)
    v_exp_f32 v148, v148
    v_exp_f32 v149, v149
    v_exp_f32 v150, v150
    v_exp_f32 v151, v151
    v_mfma_f32_32x32x8_bf16 v[104:119], v[66:67], v[40:41], v[104:119]
    v_exp_f32 v152, v152
    v_exp_f32 v153, v153
    v_exp_f32 v154, v154
    v_exp_f32 v155, v155
    v_smfmac_f32_32x32x32_bf16 v[200:215], v[76:79], v[144:151], v12
    s_add_u32 s32, s32, 165888
    s_addc_u32 s33, s33, 0
    s_sub_u32 s34, s34, 165888
    v_exp_f32 v156, v156
    v_exp_f32 v157, v157
    v_exp_f32 v158, v158
    v_exp_f32 v159, v159
    v_mfma_f32_32x32x16_bf16 v[120:135], v[52:55], v[28:31], 0
    v_exp_f32 v160, v160
    v_exp_f32 v161, v161
    v_exp_f32 v162, v162
    v_exp_f32 v163, v163
    v_smfmac_f32_32x32x32_bf16 v[216:231], v[72:75], v[152:159], v12
    v_exp_f32 v164, v164
    v_exp_f32 v165, v165
    v_exp_f32 v166, v166
    v_exp_f32 v167, v167
    v_mfma_f32_32x32x8_bf16 v[120:135], v[66:67], v[42:43], v[120:135]
    v_exp_f32 v104, v104
    v_exp_f32 v105, v105
    v_exp_f32 v106, v106
    v_exp_f32 v107, v107
    v_smfmac_f32_32x32x32_bf16 v[216:231], v[76:79], v[160:167], v12
    buffer_load_dwordx4 v[72:75], v14, s[32:35], 0 offen
    buffer_load_dwordx4 v[76:79], v15, s[32:35], 0 offen
    v_exp_f32 v108, v108
    v_exp_f32 v109, v109
    v_exp_f32 v110, v110
    v_exp_f32 v111, v111
    v_mfma_f32_32x32x16_bf16 v[136:151], v[52:55], v[32:35], 0
    v_exp_f32 v112, v112
    v_exp_f32 v113, v113
    v_exp_f32 v114, v114
    v_exp_f32 v115, v115
    v_smfmac_f32_32x32x32_bf16 v[168:183], v[80:83], v[104:111], v12
    v_exp_f32 v116, v116
    v_exp_f32 v117, v117
    v_exp_f32 v118, v118
    v_exp_f32 v119, v119
    v_mfma_f32_32x32x8_bf16 v[136:151], v[66:67], v[44:45], v[136:151]
    v_exp_f32 v120, v120
    v_exp_f32 v121, v121
    v_exp_f32 v122, v122
    v_exp_f32 v123, v123
    v_smfmac_f32_32x32x32_bf16 v[168:183], v[84:87], v[112:119], v12
    v_exp_f32 v124, v124
    v_exp_f32 v125, v125
    v_exp_f32 v126, v126
    v_exp_f32 v127, v127
    v_mfma_f32_32x32x16_bf16 v[152:167], v[52:55], v[36:39], 0
    v_exp_f32 v128, v128
    v_exp_f32 v129, v129
    v_exp_f32 v130, v130
    v_exp_f32 v131, v131
    v_smfmac_f32_32x32x32_bf16 v[184:199], v[80:83], v[120:127], v12
    v_exp_f32 v132, v132
    v_exp_f32 v133, v133
    v_exp_f32 v134, v134
    v_exp_f32 v135, v135
    v_mfma_f32_32x32x8_bf16 v[152:167], v[66:67], v[46:47], v[152:167]
    v_exp_f32 v136, v136
    v_exp_f32 v137, v137
    v_exp_f32 v138, v138
    v_exp_f32 v139, v139
    v_smfmac_f32_32x32x32_bf16 v[184:199], v[84:87], v[128:135], v12
    buffer_load_dwordx4 v[52:55], v10, s[28:31], 0 offen offset:2560
    buffer_load_dwordx4 v[64:67], v11, s[28:31], 0 offen offset:2048
    v_exp_f32 v140, v140
    v_exp_f32 v141, v141
    v_exp_f32 v142, v142
    v_exp_f32 v143, v143
    v_mfma_f32_32x32x16_bf16 v[104:119], v[56:59], v[24:27], 0
    v_exp_f32 v144, v144
    v_exp_f32 v145, v145
    v_exp_f32 v146, v146
    v_exp_f32 v147, v147
    v_smfmac_f32_32x32x32_bf16 v[200:215], v[80:83], v[136:143], v12
    s_waitcnt vmcnt(7)
    v_exp_f32 v148, v148
    v_exp_f32 v149, v149
    v_exp_f32 v150, v150
    v_exp_f32 v151, v151
    v_mfma_f32_32x32x8_bf16 v[104:119], v[68:69], v[40:41], v[104:119]
    v_exp_f32 v152, v152
    v_exp_f32 v153, v153
    v_exp_f32 v154, v154
    v_exp_f32 v155, v155
    v_smfmac_f32_32x32x32_bf16 v[200:215], v[84:87], v[144:151], v12
    v_exp_f32 v156, v156
    v_exp_f32 v157, v157
    v_exp_f32 v158, v158
    v_exp_f32 v159, v159
    v_mfma_f32_32x32x16_bf16 v[120:135], v[56:59], v[28:31], 0
    v_exp_f32 v160, v160
    v_exp_f32 v161, v161
    v_exp_f32 v162, v162
    v_exp_f32 v163, v163
    v_smfmac_f32_32x32x32_bf16 v[216:231], v[80:83], v[152:159], v12
    v_exp_f32 v164, v164
    v_exp_f32 v165, v165
    v_exp_f32 v166, v166
    v_exp_f32 v167, v167
    v_mfma_f32_32x32x8_bf16 v[120:135], v[68:69], v[42:43], v[120:135]
    v_exp_f32 v104, v104
    v_exp_f32 v105, v105
    v_exp_f32 v106, v106
    v_exp_f32 v107, v107
    v_smfmac_f32_32x32x32_bf16 v[216:231], v[84:87], v[160:167], v12
    buffer_load_dwordx4 v[80:83], v16, s[32:35], 0 offen
    buffer_load_dwordx4 v[84:87], v17, s[32:35], 0 offen
    v_exp_f32 v108, v108
    v_exp_f32 v109, v109
    v_exp_f32 v110, v110
    v_exp_f32 v111, v111
    v_mfma_f32_32x32x16_bf16 v[136:151], v[56:59], v[32:35], 0
    v_exp_f32 v112, v112
    v_exp_f32 v113, v113
    v_exp_f32 v114, v114
    v_exp_f32 v115, v115
    v_smfmac_f32_32x32x32_bf16 v[168:183], v[88:91], v[104:111], v12
    v_exp_f32 v116, v116
    v_exp_f32 v117, v117
    v_exp_f32 v118, v118
    v_exp_f32 v119, v119
    v_mfma_f32_32x32x8_bf16 v[136:151], v[68:69], v[44:45], v[136:151]
    v_exp_f32 v120, v120
    v_exp_f32 v121, v121
    v_exp_f32 v122, v122
    v_exp_f32 v123, v123
    v_smfmac_f32_32x32x32_bf16 v[168:183], v[92:95], v[112:119], v12
    v_exp_f32 v124, v124
    v_exp_f32 v125, v125
    v_exp_f32 v126, v126
    v_exp_f32 v127, v127
    v_mfma_f32_32x32x16_bf16 v[152:167], v[56:59], v[36:39], 0
    v_exp_f32 v128, v128
    v_exp_f32 v129, v129
    v_exp_f32 v130, v130
    v_exp_f32 v131, v131
    v_smfmac_f32_32x32x32_bf16 v[184:199], v[88:91], v[120:127], v12
    v_exp_f32 v132, v132
    v_exp_f32 v133, v133
    v_exp_f32 v134, v134
    v_exp_f32 v135, v135
    v_mfma_f32_32x32x8_bf16 v[152:167], v[68:69], v[46:47], v[152:167]
    v_exp_f32 v136, v136
    v_exp_f32 v137, v137
    v_exp_f32 v138, v138
    v_exp_f32 v139, v139
    v_smfmac_f32_32x32x32_bf16 v[184:199], v[92:95], v[128:135], v12
    buffer_load_dwordx4 v[56:59], v10, s[28:31], 0 offen offset:3072
    v_exp_f32 v140, v140
    v_exp_f32 v141, v141
    v_exp_f32 v142, v142
    v_exp_f32 v143, v143
    v_mfma_f32_32x32x16_bf16 v[104:119], v[60:63], v[24:27], 0
    v_exp_f32 v144, v144
    v_exp_f32 v145, v145
    v_exp_f32 v146, v146
    v_exp_f32 v147, v147
    v_smfmac_f32_32x32x32_bf16 v[200:215], v[88:91], v[136:143], v12
    s_waitcnt vmcnt(7)
    v_exp_f32 v148, v148
    v_exp_f32 v149, v149
    v_exp_f32 v150, v150
    v_exp_f32 v151, v151
    v_mfma_f32_32x32x8_bf16 v[104:119], v[70:71], v[40:41], v[104:119]
    v_exp_f32 v152, v152
    v_exp_f32 v153, v153
    v_exp_f32 v154, v154
    v_exp_f32 v155, v155
    v_smfmac_f32_32x32x32_bf16 v[200:215], v[92:95], v[144:151], v12
    v_exp_f32 v156, v156
    v_exp_f32 v157, v157
    v_exp_f32 v158, v158
    v_exp_f32 v159, v159
    v_mfma_f32_32x32x16_bf16 v[120:135], v[60:63], v[28:31], 0
    v_exp_f32 v160, v160
    v_exp_f32 v161, v161
    v_exp_f32 v162, v162
    v_exp_f32 v163, v163
    v_smfmac_f32_32x32x32_bf16 v[216:231], v[88:91], v[152:159], v12
    v_exp_f32 v164, v164
    v_exp_f32 v165, v165
    v_exp_f32 v166, v166
    v_exp_f32 v167, v167
    v_mfma_f32_32x32x8_bf16 v[120:135], v[70:71], v[42:43], v[120:135]
    v_exp_f32 v104, v104
    v_exp_f32 v105, v105
    v_exp_f32 v106, v106
    v_exp_f32 v107, v107
    v_smfmac_f32_32x32x32_bf16 v[216:231], v[92:95], v[160:167], v12
    buffer_load_dwordx4 v[88:91], v18, s[32:35], 0 offen
    buffer_load_dwordx4 v[92:95], v19, s[32:35], 0 offen
    v_exp_f32 v108, v108
    v_exp_f32 v109, v109
    v_exp_f32 v110, v110
    v_exp_f32 v111, v111
    v_mfma_f32_32x32x16_bf16 v[136:151], v[60:63], v[32:35], 0
    v_exp_f32 v112, v112
    v_exp_f32 v113, v113
    v_exp_f32 v114, v114
    v_exp_f32 v115, v115
    v_smfmac_f32_32x32x32_bf16 v[168:183], v[96:99], v[104:111], v12
    v_exp_f32 v116, v116
    v_exp_f32 v117, v117
    v_exp_f32 v118, v118
    v_exp_f32 v119, v119
    v_mfma_f32_32x32x8_bf16 v[136:151], v[70:71], v[44:45], v[136:151]
    v_exp_f32 v120, v120
    v_exp_f32 v121, v121
    v_exp_f32 v122, v122
    v_exp_f32 v123, v123
    v_smfmac_f32_32x32x32_bf16 v[168:183], v[100:103], v[112:119], v12
    v_exp_f32 v124, v124
    v_exp_f32 v125, v125
    v_exp_f32 v126, v126
    v_exp_f32 v127, v127
    v_mfma_f32_32x32x16_bf16 v[152:167], v[60:63], v[36:39], 0
    v_exp_f32 v128, v128
    v_exp_f32 v129, v129
    v_exp_f32 v130, v130
    v_exp_f32 v131, v131
    v_smfmac_f32_32x32x32_bf16 v[184:199], v[96:99], v[120:127], v12
    v_exp_f32 v132, v132
    v_exp_f32 v133, v133
    v_exp_f32 v134, v134
    v_exp_f32 v135, v135
    v_mfma_f32_32x32x8_bf16 v[152:167], v[70:71], v[46:47], v[152:167]
    v_exp_f32 v136, v136
    v_exp_f32 v137, v137
    v_exp_f32 v138, v138
    v_exp_f32 v139, v139
    v_smfmac_f32_32x32x32_bf16 v[184:199], v[100:103], v[128:135], v12
    buffer_load_dwordx4 v[60:63], v10, s[28:31], 0 offen offset:3584
    buffer_load_dwordx4 v[68:71], v11, s[28:31], 0 offen offset:3072
    v_exp_f32 v140, v140
    v_exp_f32 v141, v141
    v_exp_f32 v142, v142
    v_exp_f32 v143, v143
    v_mfma_f32_32x32x16_bf16 v[104:119], v[48:51], v[24:27], 0
    v_exp_f32 v144, v144
    v_exp_f32 v145, v145
    v_exp_f32 v146, v146
    v_exp_f32 v147, v147
    v_smfmac_f32_32x32x32_bf16 v[200:215], v[96:99], v[136:143], v12
    s_waitcnt vmcnt(7)
    v_exp_f32 v148, v148
    v_exp_f32 v149, v149
    v_exp_f32 v150, v150
    v_exp_f32 v151, v151
    v_mfma_f32_32x32x8_bf16 v[104:119], v[64:65], v[40:41], v[104:119]
    v_exp_f32 v152, v152
    v_exp_f32 v153, v153
    v_exp_f32 v154, v154
    v_exp_f32 v155, v155
    v_smfmac_f32_32x32x32_bf16 v[200:215], v[100:103], v[144:151], v12
    v_exp_f32 v156, v156
    v_exp_f32 v157, v157
    v_exp_f32 v158, v158
    v_exp_f32 v159, v159
    v_mfma_f32_32x32x16_bf16 v[120:135], v[48:51], v[28:31], 0
    v_exp_f32 v160, v160
    v_exp_f32 v161, v161
    v_exp_f32 v162, v162
    v_exp_f32 v163, v163
    v_smfmac_f32_32x32x32_bf16 v[216:231], v[96:99], v[152:159], v12
    s_add_u32 s28, s28, 2048
    s_addc_u32 s29, s29, 0
    s_bitcmp1_b32 9, s58
    s_cbranch_scc1 L_hook
L_hookr:
    v_exp_f32 v164, v164
    v_exp_f32 v165, v165
    v_exp_f32 v166, v166
    v_exp_f32 v167, v167
    v_mfma_f32_32x32x8_bf16 v[120:135], v[64:65], v[42:43], v[120:135]
    v_exp_f32 v104, v104
    v_exp_f32 v105, v105
    v_exp_f32 v106, v106
    v_exp_f32 v107, v107
    v_smfmac_f32_32x32x32_bf16 v[216:231], v[100:103], v[160:167], v12
    buffer_load_dwordx4 v[96:99], v20, s[32:35], 0 offen
    buffer_load_dwordx4 v[100:103], v21, s[32:35], 0 offen
    v_exp_f32 v108, v108
    v_exp_f32 v109, v109
    v_exp_f32 v110, v110
    v_exp_f32 v111, v111
    v_mfma_f32_32x32x16_bf16 v[136:151], v[48:51], v[32:35], 0
    v_exp_f32 v112, v112
    v_exp_f32 v113, v113
    v_exp_f32 v114, v114
    v_exp_f32 v115, v115
    v_smfmac_f32_32x32x32_bf16 v[168:183], v[72:75], v[104:111], v12
    v_exp_f32 v116, v116
    v_exp_f32 v117, v117
    v_exp_f32 v118, v118
    v_exp_f32 v119, v119
    v_mfma_f32_32x32x8_bf16 v[136:151], v[64:65], v[44:45], v[136:151]
    v_exp_f32 v120, v120
    v_exp_f32 v121, v121
    v_exp_f32 v122, v122
    v_exp_f32 v123, v123
    v_smfmac_f32_32x32x32_bf16 v[168:183], v[76:79], v[112:119], v12
    v_exp_f32 v124, v124
    v_exp_f32 v125, v125
    v_exp_f32 v126, v126
    v_exp_f32 v127, v127
    v_mfma_f32_32x32x16_bf16 v[152:167], v[48:51], v[36:39], 0
    v_exp_f32 v128, v128
    v_exp_f32 v129, v129
    v_exp_f32 v130, v130
    v_exp_f32 v131, v131
    v_smfmac_f32_32x32x32_bf16 v[184:199], v[72:75], v[120:127], v12
    v_exp_f32 v132, v132
    v_exp_f32 v133, v133
    v_exp_f32 v134, v134
    v_exp_f32 v135, v135
    v_mfma_f32_32x32x8_bf16 v[152:167], v[64:65], v[46:47], v[152:167]
    v_exp_f32 v136, v136
    v_exp_f32 v137, v137
    v_exp_f32 v138, v138
    v_exp_f32 v139, v139
    v_smfmac_f32_32x32x32_bf16 v[184:199], v[76:79], v[128:135], v12
    buffer_load_dwordx4 v[48:51], v10, s[28:31], 0 offen offset:2048
    v_exp_f32 v140, v140
    v_exp_f32 v141, v141
    v_exp_f32 v142, v142
    v_exp_f32 v143, v143
    v_mfma_f32_32x32x16_bf16 v[104:119], v[52:55], v[24:27], 0
    v_exp_f32 v144, v144
    v_exp_f32 v145, v145
    v_exp_f32 v146, v146
    v_exp_f32 v147, v147
    v_smfmac_f32_32x32x32_bf16 v[200:215], v[72:75], v[136:143], v12
    s_waitcnt vmcnt(7)
    v_exp_f32 v148, v148
    v_exp_f32 v149, v149
    v_exp_f32 v150, v150
    v_exp_f32 v151, v151
    v_mfma_f32_32x32x8_bf16 v[104:119], v[66:67], v[40:41], v[104:119]
    v_exp_f32 v152, v152
    v_exp_f32 v153, v153
    v_exp_f32 v154, v154
    v_exp_f32 v155, v155
    v_smfmac_f32_32x32x32_bf16 v[200:215], v[76:79], v[144:151], v12
    s_add_u32 s32, s32, 165888
    s_addc_u32 s33, s33, 0
    s_sub_u32 s34, s34, 165888
    v_exp_f32 v156, v156
    v_exp_f32 v157, v157
    v_exp_f32 v158, v158
    v_exp_f32 v159, v159
    v_mfma_f32_32x32x16_bf16 v[120:135], v[52:55], v[28:31], 0
    v_exp_f32 v160, v160
    v_exp_f32 v161, v161
    v_exp_f32 v162, v162
    v_exp_f32 v163, v163
    v_smfmac_f32_32x32x32_bf16 v[216:231], v[72:75], v[152:159], v12
    v_exp_f32 v164, v164
    v_exp_f32 v165, v165
    v_exp_f32 v166, v166
    v_exp_f32 v167, v167
    v_mfma_f32_32x32x8_bf16 v[120:135], v[66:67], v[42:43], v[120:135]
    v_exp_f32 v104, v104
    v_exp_f32 v105, v105
    v_exp_f32 v106, v106
    v_exp_f32 v107, v107
    v_smfmac_f32_32x32x32_bf16 v[216:231], v[76:79], v[160:167], v12
    buffer_load_dwordx4 v[72:75], v14, s[32:35], 0 offen
    buffer_load_dwordx4 v[76:79], v15, s[32:35], 0 offen
    v_exp_f32 v108, v108
    v_exp_f32 v109, v109
    v_exp_f32 v110, v110
    v_exp_f32 v111, v111
    v_mfma_f32_32x32x16_bf16 v[136:151], v[52:55], v[32:35], 0
    v_exp_f32 v112, v112
    v_exp_f32 v113, v113
    v_exp_f32 v114, v114
    v_exp_f32 v115, v115
    v_smfmac_f32_32x32x32_bf16 v[168:183], v[80:83], v[104:111], v12
    v_exp_f32 v116, v116
    v_exp_f32 v117, v117
    v_exp_f32 v118, v118
    v_exp_f32 v119, v119
    v_mfma_f32_32x32x8_bf16 v[136:151], v[66:67], v[44:45], v[136:151]
    v_exp_f32 v120, v120
    v_exp_f32 v121, v121
    v_exp_f32 v122, v122
    v_exp_f32 v123, v123
    v_smfmac_f32_32x32x32_bf16 v[168:183], v[84:87], v[112:119], v12
    v_exp_f32 v124, v124
    v_exp_f32 v125, v125
    v_exp_f32 v126, v126
    v_exp_f32 v127, v127
    v_mfma_f32_32x32x16_bf16 v[152:167], v[52:55], v[36:39], 0
    v_exp_f32 v128, v128
    v_exp_f32 v129, v129
    v_exp_f32 v130, v130
    v_exp_f32 v131, v131
    v_smfmac_f32_32x32x32_bf16 v[184:199], v[80:83], v[120:127], v12
    v_exp_f32 v132, v132
    v_exp_f32 v133, v133
    v_exp_f32 v134, v134
    v_exp_f32 v135, v135
    v_mfma_f32_32x32x8_bf16 v[152:167], v[66:67], v[46:47], v[152:167]
    v_exp_f32 v136, v136
    v_exp_f32 v137, v137
    v_exp_f32 v138, v138
    v_exp_f32 v139, v139
    v_smfmac_f32_32x32x32_bf16 v[184:199], v[84:87], v[128:135], v12
    buffer_load_dwordx4 v[52:55], v10, s[28:31], 0 offen offset:2560
    buffer_load_dwordx4 v[64:67], v11, s[28:31], 0 offen offset:2048
    v_exp_f32 v140, v140
    v_exp_f32 v141, v141
    v_exp_f32 v142, v142
    v_exp_f32 v143, v143
    v_mfma_f32_32x32x16_bf16 v[104:119], v[56:59], v[24:27], 0
    v_exp_f32 v144, v144
    v_exp_f32 v145, v145
    v_exp_f32 v146, v146
    v_exp_f32 v147, v147
    v_smfmac_f32_32x32x32_bf16 v[200:215], v[80:83], v[136:143], v12
    s_waitcnt vmcnt(7)
    v_exp_f32 v148, v148
    v_exp_f32 v149, v149
    v_exp_f32 v150, v150
    v_exp_f32 v151, v151
    v_mfma_f32_32x32x8_bf16 v[104:119], v[68:69], v[40:41], v[104:119]
    v_exp_f32 v152, v152
    v_exp_f32 v153, v153
    v_exp_f32 v154, v154
    v_exp_f32 v155, v155
    v_smfmac_f32_32x32x32_bf16 v[200:215], v[84:87], v[144:151], v12
    v_exp_f32 v156, v156
    v_exp_f32 v157, v157
    v_exp_f32 v158, v158
    v_exp_f32 v159, v159
    v_mfma_f32_32x32x16_bf16 v[120:135], v[56:59], v[28:31], 0
    v_exp_f32 v160, v160
    v_exp_f32 v161, v161
    v_exp_f32 v162, v162
    v_exp_f32 v163, v163
    v_smfmac_f32_32x32x32_bf16 v[216:231], v[80:83], v[152:159], v12
    v_exp_f32 v164, v164
    v_exp_f32 v165, v165
    v_exp_f32 v166, v166
    v_exp_f32 v167, v167
    v_mfma_f32_32x32x8_bf16 v[120:135], v[68:69], v[42:43], v[120:135]
    v_exp_f32 v104, v104
    v_exp_f32 v105, v105
    v_exp_f32 v106, v106
    v_exp_f32 v107, v107
    v_smfmac_f32_32x32x32_bf16 v[216:231], v[84:87], v[160:167], v12
    buffer_load_dwordx4 v[80:83], v16, s[32:35], 0 offen
    buffer_load_dwordx4 v[84:87], v17, s[32:35], 0 offen
    v_exp_f32 v108, v108
    v_exp_f32 v109, v109
    v_exp_f32 v110, v110
    v_exp_f32 v111, v111
    v_mfma_f32_32x32x16_bf16 v[136:151], v[56:59], v[32:35], 0
    v_exp_f32 v112, v112
    v_exp_f32 v113, v113
    v_exp_f32 v114, v114
    v_exp_f32 v115, v115
    v_smfmac_f32_32x32x32_bf16 v[168:183], v[88:91], v[104:111], v12
    v_exp_f32 v116, v116
    v_exp_f32 v117, v117
    v_exp_f32 v118, v118
    v_exp_f32 v119, v119
    v_mfma_f32_32x32x8_bf16 v[136:151], v[68:69], v[44:45], v[136:151]
    v_exp_f32 v120, v120
    v_exp_f32 v121, v121
    v_exp_f32 v122, v122
    v_exp_f32 v123, v123
    v_smfmac_f32_32x32x32_bf16 v[168:183], v[92:95], v[112:119], v12
    v_exp_f32 v124, v124
    v_exp_f32 v125, v125
    v_exp_f32 v126, v126
    v_exp_f32 v127, v127
    v_mfma_f32_32x32x16_bf16 v[152:167], v[56:59], v[36:39], 0
    v_exp_f32 v128, v128
    v_exp_f32 v129, v129
    v_exp_f32 v130, v130
    v_exp_f32 v131, v131
    v_smfmac_f32_32x32x32_bf16 v[184:199], v[88:91], v[120:127], v12
    v_exp_f32 v132, v132
    v_exp_f32 v133, v133
    v_exp_f32 v134, v134
    v_exp_f32 v135, v135
    v_mfma_f32_32x32x8_bf16 v[152:167], v[68:69], v[46:47], v[152:167]
    v_exp_f32 v136, v136
    v_exp_f32 v137, v137
    v_exp_f32 v138, v138
    v_exp_f32 v139, v139
    v_smfmac_f32_32x32x32_bf16 v[184:199], v[92:95], v[128:135], v12
    buffer_load_dwordx4 v[56:59], v10, s[28:31], 0 offen offset:3072
    v_exp_f32 v140, v140
    v_exp_f32 v141, v141
    v_exp_f32 v142, v142
    v_exp_f32 v143, v143
    v_mfma_f32_32x32x16_bf16 v[104:119], v[60:63], v[24:27], 0
    v_exp_f32 v144, v144
    v_exp_f32 v145, v145
    v_exp_f32 v146, v146
    v_exp_f32 v147, v147
    v_smfmac_f32_32x32x32_bf16 v[200:215], v[88:91], v[136:143], v12
    s_waitcnt vmcnt(7)
    v_exp_f32 v148, v148
    v_exp_f32 v149, v149
    v_exp_f32 v150, v150
    v_exp_f32 v151, v151
    v_mfma_f32_32x32x8_bf16 v[104:119], v[70:71], v[40:41], v[104:119]
    v_exp_f32 v152, v152
    v_exp_f32 v153, v153
    v_exp_f32 v154, v154
    v_exp_f32 v155, v155
    v_smfmac_f32_32x32x32_bf16 v[200:215], v[92:95], v[144:151], v12
    v_exp_f32 v156, v156
    v_exp_f32 v157, v157
    v_exp_f32 v158, v158
    v_exp_f32 v159, v159
    v_mfma_f32_32x32x16_bf16 v[120:135], v[60:63], v[28:31], 0
    v_exp_f32 v160, v160
    v_exp_f32 v161, v161
    v_exp_f32 v162, v162
    v_exp_f32 v163, v163
    v_smfmac_f32_32x32x32_bf16 v[216:231], v[88:91], v[152:159], v12
    v_exp_f32 v164, v164
    v_exp_f32 v165, v165
    v_exp_f32 v166, v166
    v_exp_f32 v167, v167
    v_mfma_f32_32x32x8_bf16 v[120:135], v[70:71], v[42:43], v[120:135]
    v_exp_f32 v104, v104
    v_exp_f32 v105, v105
    v_exp_f32 v106, v106
    v_exp_f32 v107, v107
    v_smfmac_f32_32x32x32_bf16 v[216:231], v[92:95], v[160:167], v12
    buffer_load_dwordx4 v[88:91], v18, s[32:35], 0 offen
    buffer_load_dwordx4 v[92:95], v19, s[32:35], 0 offen
    v_exp_f32 v108, v108
    v_exp_f32 v109, v109
    v_exp_f32 v110, v110
    v_exp_f32 v111, v111
    v_mfma_f32_32x32x16_bf16 v[136:151], v[60:63], v[32:35], 0
    v_exp_f32 v112, v112
    v_exp_f32 v113, v113
    v_exp_f32 v114, v114
    v_exp_f32 v115, v115
    v_smfmac_f32_32x32x32_bf16 v[168:183], v[96:99], v[104:111], v12
    v_exp_f32 v116, v116
    v_exp_f32 v117, v117
    v_exp_f32 v118, v118
    v_exp_f32 v119, v119
    v_mfma_f32_32x32x8_bf16 v[136:151], v[70:71], v[44:45], v[136:151]
    v_exp_f32 v120, v120
    v_exp_f32 v121, v121
    v_exp_f32 v122, v122
    v_exp_f32 v123, v123
    v_smfmac_f32_32x32x32_bf16 v[168:183], v[100:103], v[112:119], v12
    v_exp_f32 v124, v124
    v_exp_f32 v125, v125
    v_exp_f32 v126, v126
    v_exp_f32 v127, v127
    v_mfma_f32_32x32x16_bf16 v[152:167], v[60:63], v[36:39], 0
    s_add_u32 s58, s58, 1
    s_cmp_lg_u32 s58, 4
    v_exp_f32 v128, v128
    v_exp_f32 v129, v129
    v_exp_f32 v130, v130
    v_exp_f32 v131, v131
    v_smfmac_f32_32x32x32_bf16 v[184:199], v[96:99], v[120:127], v12
    s_cbranch_scc1 L_loop
    v_exp_f32 v132, v132
    v_exp_f32 v133, v133
    v_exp_f32 v134, v134
    v_exp_f32 v135, v135
    v_mfma_f32_32x32x8_bf16 v[152:167], v[70:71], v[46:47], v[152:167]
    v_exp_f32 v136, v136
    v_exp_f32 v137, v137
    v_exp_f32 v138, v138
    v_exp_f32 v139, v139
    v_smfmac_f32_32x32x32_bf16 v[184:199], v[100:103], v[128:135], v12
    ds_write_b128 v240, v[168:171] offset:0
    ds_write_b128 v240, v[172:175] offset:1024
    ds_write_b128 v240, v[176:179] offset:2048
    v_exp_f32 v140, v140
    v_exp_f32 v141, v141
    v_exp_f32 v142, v142
    v_exp_f32 v143, v143
    v_exp_f32 v144, v144
    v_exp_f32 v145, v145
    v_exp_f32 v146, v146
    v_exp_f32 v147, v147
    v_smfmac_f32_32x32x32_bf16 v[200:215], v[96:99], v[136:143], v12
    ds_write_b128 v240, v[184:187] offset:3072
    ds_write_b128 v240, v[188:191] offset:4096
    ds_write_b128 v240, v[192:195] offset:5120
    v_exp_f32 v148, v148
    v_exp_f32 v149, v149
    v_exp_f32 v150, v150
    v_exp_f32 v151, v151
    v_exp_f32 v152, v152
    v_exp_f32 v153, v153
    v_exp_f32 v154, v154
    v_exp_f32 v155, v155
    v_smfmac_f32_32x32x32_bf16 v[200:215], v[100:103], v[144:151], v12
    s_waitcnt lgkmcnt(0)
    ds_write_b32 v245, v247 offset:32
    v_exp_f32 v156, v156
    v_exp_f32 v157, v157
    v_exp_f32 v158, v158
    v_exp_f32 v159, v159
    v_exp_f32 v160, v160
    v_exp_f32 v161, v161
    v_exp_f32 v162, v162
    v_exp_f32 v163, v163
    v_smfmac_f32_32x32x32_bf16 v[216:231], v[96:99], v[152:159], v12
    ds_read_b32 v2, v246 offset:32
    ds_read_b32 v3, v8 offset:48
    v_exp_f32 v164, v164
    v_exp_f32 v165, v165
    v_exp_f32 v166, v166
    v_exp_f32 v167, v167
    s_mov_b32 s59, 1600000
L_wx0:
    s_nop 0
    v_smfmac_f32_32x32x32_bf16 v[216:231], v[100:103], v[160:167], v12
L_wx:
    s_waitcnt lgkmcnt(0)
    v_add_u32 v2, v2, v3
    s_nop 0
    v_readfirstlane_b32 s56, v2
    s_nop 1
    s_cmp_eq_u32 s56, 5
    s_cbranch_scc0 L_wxs
L_wxd:
    ds_read_b128 v[104:107], v241 offset:0
    ds_read_b128 v[108:111], v241 offset:1024
    ds_read_b128 v[112:115], v241 offset:2048
    ds_read_b128 v[116:119], v241 offset:3072
    ds_read_b128 v[120:123], v241 offset:4096
    ds_read_b128 v[124:127], v241 offset:5120
    s_waitcnt lgkmcnt(3)
    v_pk_add_f32 v[208:209], v[208:209], v[112:113]
    v_pk_add_f32 v[210:211], v[210:211], v[114:115]
    v_pk_add_f32 v[200:201], v[200:201], v[104:105]
    v_pk_add_f32 v[202:203], v[202:203], v[106:107]
    v_pk_add_f32 v[204:205], v[204:205], v[108:109]
    v_pk_add_f32 v[206:207], v[206:207], v[110:111]
    v_mov_b32 v212, v208
    v_mov_b32 v213, v208
    v_pk_mul_f32 v[214:215], v[200:201], 0
    v_pk_fma_f32 v[214:215], v[202:203], 0, v[214:215]
    v_permlane32_swap_b32 v213, v212
    v_pk_fma_f32 v[214:215], v[204:205], 0, v[214:215]
    v_pk_fma_f32 v[214:215], v[206:207], 0, v[214:215]
    v_pk_fma_f32 v[214:215], v[208:209], 0, v[214:215]
    v_pk_fma_f32 v[214:215], v[210:211], 0, v[214:215]
    v_add_f32 v13, v214, v215
    v_add_f32 v13, v13, v212
    v_cmp_nge_f32 vcc, 0x71800000, v13
    s_mov_b32 s56, 0x21800000
    v_cmp_gt_f32 s[58:59], s56, v13
    s_nop 1
    s_or_b64 vcc, vcc, s[58:59]
    s_cbranch_scc1 L_sl0
L_fin0:
    v_rcp_f32 v13, v212
    s_waitcnt vmcnt(0)
    v_mul_f32 v214, v13, v22
    v_pk_mul_f32 v[200:201], v[200:201], v[214:215] op_sel_hi:[1,0]
    v_pk_mul_f32 v[202:203], v[202:203], v[214:215] op_sel_hi:[1,0]
    v_pk_mul_f32 v[204:205], v[204:205], v[214:215] op_sel_hi:[1,0]
    v_pk_mul_f32 v[206:207], v[206:207], v[214:215] op_sel_hi:[1,0]
    v_pk_mul_f32 v[208:209], v[208:209], v[214:215] op_sel_hi:[1,0]
    v_pk_mul_f32 v[210:211], v[210:211], v[214:215] op_sel_hi:[1,0]
    v_cvt_pk_bf16_f32 v128, v200, v201
    v_cvt_pk_bf16_f32 v129, v202, v203
    v_cvt_pk_bf16_f32 v130, v204, v205
    v_cvt_pk_bf16_f32 v131, v206, v207
    v_cvt_pk_bf16_f32 v132, v208, v209
    v_cvt_pk_bf16_f32 v133, v210, v211
    v_min_u32 v128, -2, v128
    v_min_u32 v129, -2, v129
    v_min_u32 v130, -2, v130
    v_min_u32 v131, -2, v131
    v_min_u32 v132, -2, v132
    v_min_u32 v133, -2, v133
    buffer_store_dwordx4 v[128:131], v10, s[36:39], s51 offen offset:0 sc1
    s_mov_b64 exec, s[60:61]
    buffer_store_dwordx2 v[132:133], v248, s[36:39], s51 offen offset:0 sc1
    s_mov_b64 exec, -1
    s_waitcnt lgkmcnt(0)
    v_pk_add_f32 v[224:225], v[224:225], v[124:125]
    v_pk_add_f32 v[226:227], v[226:227], v[126:127]
    v_pk_add_f32 v[216:217], v[216:217], v[116:117]
    v_pk_add_f32 v[218:219], v[218:219], v[118:119]
    v_pk_add_f32 v[220:221], v[220:221], v[120:121]
    v_pk_add_f32 v[222:223], v[222:223], v[122:123]
    v_mov_b32 v228, v224
    v_mov_b32 v229, v224
    v_pk_mul_f32 v[230:231], v[216:217], 0
    v_pk_fma_f32 v[230:231], v[218:219], 0, v[230:231]
    v_permlane32_swap_b32 v229, v228
    v_pk_fma_f32 v[230:231], v[220:221], 0, v[230:231]
    v_pk_fma_f32 v[230:231], v[222:223], 0, v[230:231]
    v_pk_fma_f32 v[230:231], v[224:225], 0, v[230:231]
    v_pk_fma_f32 v[230:231], v[226:227], 0, v[230:231]
    v_add_f32 v13, v230, v231
    v_add_f32 v13, v13, v228
    v_cmp_nge_f32 vcc, 0x71800000, v13
    s_mov_b32 s56, 0x21800000
    v_cmp_gt_f32 s[58:59], s56, v13
    s_nop 1
    s_or_b64 vcc, vcc, s[58:59]
    s_cbranch_scc1 L_sl1
L_fin1:
    v_rcp_f32 v13, v228
    s_nop 0
    v_mul_f32 v230, v13, v23
    v_pk_mul_f32 v[216:217], v[216:217], v[230:231] op_sel_hi:[1,0]
    v_pk_mul_f32 v[218:219], v[218:219], v[230:231] op_sel_hi:[1,0]
    v_pk_mul_f32 v[220:221], v[220:221], v[230:231] op_sel_hi:[1,0]
    v_pk_mul_f32 v[222:223], v[222:223], v[230:231] op_sel_hi:[1,0]
    v_pk_mul_f32 v[224:225], v[224:225], v[230:231] op_sel_hi:[1,0]
    v_pk_mul_f32 v[226:227], v[226:227], v[230:231] op_sel_hi:[1,0]
    v_cvt_pk_bf16_f32 v136, v216, v217
    v_cvt_pk_bf16_f32 v137, v218, v219
    v_cvt_pk_bf16_f32 v138, v220, v221
    v_cvt_pk_bf16_f32 v139, v222, v223
    v_cvt_pk_bf16_f32 v140, v224, v225
    v_cvt_pk_bf16_f32 v141, v226, v227
    v_min_u32 v136, -2, v136
    v_min_u32 v137, -2, v137
    v_min_u32 v138, -2, v138
    v_min_u32 v139, -2, v139
    v_min_u32 v140, -2, v140
    v_min_u32 v141, -2, v141
    buffer_store_dwordx4 v[136:139], v10, s[36:39], s51 offen offset:512 sc1
    s_mov_b64 exec, s[60:61]
    buffer_store_dwordx2 v[140:141], v248, s[36:39], s51 offen offset:512 sc1
    s_mov_b64 exec, -1
    ds_read_b64_tr_b16 v[48:49], v242 offset:0
    ds_read_b64_tr_b16 v[50:51], v242 offset:2560
    ds_read_b64_tr_b16 v[52:53], v242 offset:32
    ds_read_b64_tr_b16 v[54:55], v242 offset:2592
    ds_read_b64_tr_b16 v[56:57], v242 offset:64
    ds_read_b64_tr_b16 v[58:59], v242 offset:2624
    ds_read_b64_tr_b16 v[60:61], v242 offset:96
    ds_read_b64_tr_b16 v[62:63], v242 offset:2656
    ds_read_b64_tr_b16 v[64:65], v242 offset:128
    ds_read_b64_tr_b16 v[66:67], v242 offset:2688
    ds_read_b64_tr_b16 v[68:69], v242 offset:5120
    ds_read_b64_tr_b16 v[70:71], v242 offset:7680
    ds_read_b64_tr_b16 v[72:73], v242 offset:5152
    ds_read_b64_tr_b16 v[74:75], v242 offset:7712
    ds_read_b64_tr_b16 v[76:77], v242 offset:5184
    ds_read_b64_tr_b16 v[78:79], v242 offset:7744
    ds_read_b64_tr_b16 v[80:81], v242 offset:5216
    ds_read_b64_tr_b16 v[82:83], v242 offset:7776
    ds_read_b64_tr_b16 v[84:85], v242 offset:5248
    ds_read_b64_tr_b16 v[86:87], v242 offset:7808
    ds_read_b64_tr_b16 v[88:89], v242 offset:10240
    ds_read_b64_tr_b16 v[90:91], v242 offset:12800
    ds_read_b64_tr_b16 v[92:93], v242 offset:10272
    ds_read_b64_tr_b16 v[94:95], v242 offset:12832
    ds_read_b64_tr_b16 v[96:97], v242 offset:10304
    ds_read_b64_tr_b16 v[98:99], v242 offset:12864
    ds_read_b64_tr_b16 v[100:101], v242 offset:10336
    ds_read_b64_tr_b16 v[102:103], v242 offset:12896
    ds_read_b64_tr_b16 v[104:105], v242 offset:10368
    ds_read_b64_tr_b16 v[106:107], v242 offset:12928
    ds_read_b64_tr_b16 v[108:109], v242 offset:15360
    ds_read_b64_tr_b16 v[110:111], v242 offset:17920
    ds_read_b64_tr_b16 v[112:113], v242 offset:15392
    ds_read_b64_tr_b16 v[114:115], v242 offset:17952
    ds_read_b64_tr_b16 v[116:117], v242 offset:15424
    ds_read_b64_tr_b16 v[118:119], v242 offset:17984
    ds_read_b64_tr_b16 v[120:121], v242 offset:15456
    ds_read_b64_tr_b16 v[122:123], v242 offset:18016
    ds_read_b64_tr_b16 v[124:125], v242 offset:15488
    ds_read_b64_tr_b16 v[126:127], v242 offset:18048
    v_add_u32 v244, 3072, v241
    s_waitcnt vmcnt(0)
    s_barrier
    s_mov_b32 s56, 0
    buffer_load_dwordx4 v[200:203], v238, s[40:43], s56 offen sc1
    s_mov_b32 s56, 131072
    buffer_load_dwordx4 v[204:207], v238, s[40:43], s56 offen sc1
    s_mov_b32 s56, 262144
    buffer_load_dwordx4 v[208:211], v238, s[40:43], s56 offen sc1
    s_mov_b32 s56, 393216
    buffer_load_dwordx4 v[212:215], v238, s[40:43], s56 offen sc1
    s_mov_b32 s36, s22
    s_and_b32 s37, s23, 0xffff
    s_mov_b32 s38, 0x280000
    s_mov_b32 s39, 0x20000
    s_mov_b32 s59, 200000
L_cst0:
    s_waitcnt vmcnt(3)
    v_max3_u32 v2, v200, v201, v202
    v_max_u32 v2, v2, v203
    v_cmp_eq_u32 vcc, -1, v2
    s_nop 1
    s_cmp_eq_u64 vcc, 0
    s_cbranch_scc0 L_cbad0
L_cok0:
    s_mov_b32 s56, 524288
    buffer_load_dwordx4 v[216:219], v238, s[40:43], s56 offen sc1
    s_waitcnt lgkmcnt(15)
    v_mfma_f32_16x16x32_bf16 v[24:27], v[48:51], v[200:203], 0
    v_mfma_f32_16x16x32_bf16 v[28:31], v[52:55], v[200:203], 0
    v_mfma_f32_16x16x32_bf16 v[32:35], v[56:59], v[200:203], 0
    v_mfma_f32_16x16x32_bf16 v[36:39], v[60:63], v[200:203], 0
    v_mfma_f32_16x16x32_bf16 v[40:43], v[64:67], v[200:203], 0
    ds_read_b64_tr_b16 v[168:169], v242 offset:20480
    ds_read_b64_tr_b16 v[170:171], v242 offset:23040
    ds_read_b64_tr_b16 v[172:173], v242 offset:20512
    ds_read_b64_tr_b16 v[174:175], v242 offset:23072
    ds_read_b64_tr_b16 v[176:177], v242 offset:20544
    ds_read_b64_tr_b16 v[178:179], v242 offset:23104
    ds_read_b64_tr_b16 v[180:181], v242 offset:20576
    ds_read_b64_tr_b16 v[182:183], v242 offset:23136
    ds_read_b64_tr_b16 v[184:185], v242 offset:20608
    ds_read_b64_tr_b16 v[186:187], v242 offset:23168
L_cst1:
    s_waitcnt vmcnt(3)
    v_max3_u32 v2, v204, v205, v206
    v_max_u32 v2, v2, v207
    v_cmp_eq_u32 vcc, -1, v2
    s_nop 1
    s_cmp_eq_u64 vcc, 0
    s_cbranch_scc0 L_cbad1
L_cok1:
    s_mov_b32 s56, 655360
    buffer_load_dwordx4 v[220:223], v238, s[40:43], s56 offen sc1
    s_waitcnt lgkmcnt(15)
    v_mfma_f32_16x16x32_bf16 v[24:27], v[68:71], v[204:207], v[24:27]
    v_mfma_f32_16x16x32_bf16 v[28:31], v[72:75], v[204:207], v[28:31]
    v_mfma_f32_16x16x32_bf16 v[32:35], v[76:79], v[204:207], v[32:35]
    v_mfma_f32_16x16x32_bf16 v[36:39], v[80:83], v[204:207], v[36:39]
    v_mfma_f32_16x16x32_bf16 v[40:43], v[84:87], v[204:207], v[40:43]
    ds_read_b64_tr_b16 v[48:49], v242 offset:25600
    ds_read_b64_tr_b16 v[50:51], v242 offset:28160
    ds_read_b64_tr_b16 v[52:53], v242 offset:25632
    ds_read_b64_tr_b16 v[54:55], v242 offset:28192
    ds_read_b64_tr_b16 v[56:57], v242 offset:25664
    ds_read_b64_tr_b16 v[58:59], v242 offset:28224
    ds_read_b64_tr_b16 v[60:61], v242 offset:25696
    ds_read_b64_tr_b16 v[62:63], v242 offset:28256
    ds_read_b64_tr_b16 v[64:65], v242 offset:25728
    ds_read_b64_tr_b16 v[66:67], v242 offset:28288
L_cst2:
    s_waitcnt vmcnt(3)
    v_max3_u32 v2, v208, v209, v210
    v_max_u32 v2, v2, v211
    v_cmp_eq_u32 vcc, -1, v2
    s_nop 1
    s_cmp_eq_u64 vcc, 0
    s_cbranch_scc0 L_cbad2
L_cok2:
    s_mov_b32 s56, 786432
    buffer_load_dwordx4 v[224:227], v238, s[40:43], s56 offen sc1
    s_waitcnt lgkmcnt(15)
    v_mfma_f32_16x16x32_bf16 v[24:27], v[88:91], v[208:211], v[24:27]
    v_mfma_f32_16x16x32_bf16 v[28:31], v[92:95], v[208:211], v[28:31]
    v_mfma_f32_16x16x32_bf16 v[32:35], v[96:99], v[208:211], v[32:35]
    v_mfma_f32_16x16x32_bf16 v[36:39], v[100:103], v[208:211], v[36:39]
    v_mfma_f32_16x16x32_bf16 v[40:43], v[104:107], v[208:211], v[40:43]
    ds_read_b64_tr_b16 v[68:69], v242 offset:30720
    ds_read_b64_tr_b16 v[70:71], v242 offset:33280
    ds_read_b64_tr_b16 v[72:73], v242 offset:30752
    ds_read_b64_tr_b16 v[74:75], v242 offset:33312
    ds_read_b64_tr_b16 v[76:77], v242 offset:30784
    ds_read_b64_tr_b16 v[78:79], v242 offset:33344
    ds_read_b64_tr_b16 v[80:81], v242 offset:30816
    ds_read_b64_tr_b16 v[82:83], v242 offset:33376
    ds_read_b64_tr_b16 v[84:85], v242 offset:30848
    ds_read_b64_tr_b16 v[86:87], v242 offset:33408
L_cst3:
    s_waitcnt vmcnt(3)
    v_max3_u32 v2, v212, v213, v214
    v_max_u32 v2, v2, v215
    v_cmp_eq_u32 vcc, -1, v2
    s_nop 1
    s_cmp_eq_u64 vcc, 0
    s_cbranch_scc0 L_cbad3
L_cok3:
    s_mov_b32 s56, 917504
    buffer_load_dwordx4 v[228:231], v238, s[40:43], s56 offen sc1
    s_waitcnt lgkmcnt(15)
    v_mfma_f32_16x16x32_bf16 v[24:27], v[108:111], v[212:215], v[24:27]
    v_mfma_f32_16x16x32_bf16 v[28:31], v[112:115], v[212:215], v[28:31]
    v_mfma_f32_16x16x32_bf16 v[32:35], v[116:119], v[212:215], v[32:35]
    v_mfma_f32_16x16x32_bf16 v[36:39], v[120:123], v[212:215], v[36:39]
    v_mfma_f32_16x16x32_bf16 v[40:43], v[124:127], v[212:215], v[40:43]
    ds_read_b64_tr_b16 v[88:89], v242 offset:35840
    ds_read_b64_tr_b16 v[90:91], v242 offset:38400
    ds_read_b64_tr_b16 v[92:93], v242 offset:35872
    ds_read_b64_tr_b16 v[94:95], v242 offset:38432
    ds_read_b64_tr_b16 v[96:97], v242 offset:35904
    ds_read_b64_tr_b16 v[98:99], v242 offset:38464
    ds_read_b64_tr_b16 v[100:101], v242 offset:35936
    ds_read_b64_tr_b16 v[102:103], v242 offset:38496
    ds_read_b64_tr_b16 v[104:105], v242 offset:35968
    ds_read_b64_tr_b16 v[106:107], v242 offset:38528
L_cst4:
    s_waitcnt vmcnt(3)
    v_max3_u32 v2, v216, v217, v218
    v_max_u32 v2, v2, v219
    v_cmp_eq_u32 vcc, -1, v2
    s_nop 1
    s_cmp_eq_u64 vcc, 0
    s_cbranch_scc0 L_cbad4
L_cok4:
    s_waitcnt lgkmcnt(15)
    v_mfma_f32_16x16x32_bf16 v[24:27], v[168:171], v[216:219], v[24:27]
    v_mfma_f32_16x16x32_bf16 v[28:31], v[172:175], v[216:219], v[28:31]
    v_mfma_f32_16x16x32_bf16 v[32:35], v[176:179], v[216:219], v[32:35]
    v_mfma_f32_16x16x32_bf16 v[36:39], v[180:183], v[216:219], v[36:39]
    v_mfma_f32_16x16x32_bf16 v[40:43], v[184:187], v[216:219], v[40:43]
L_cst5:
    s_waitcnt vmcnt(2)
    v_max3_u32 v2, v220, v221, v222
    v_max_u32 v2, v2, v223
    v_cmp_eq_u32 vcc, -1, v2
    s_nop 1
    s_cmp_eq_u64 vcc, 0
    s_cbranch_scc0 L_cbad5
L_cok5:
    s_waitcnt lgkmcnt(15)
    v_mfma_f32_16x16x32_bf16 v[24:27], v[48:51], v[220:223], v[24:27]
    v_mfma_f32_16x16x32_bf16 v[28:31], v[52:55], v[220:223], v[28:31]
    v_mfma_f32_16x16x32_bf16 v[32:35], v[56:59], v[220:223], v[32:35]
    v_mfma_f32_16x16x32_bf16 v[36:39], v[60:63], v[220:223], v[36:39]
    v_mfma_f32_16x16x32_bf16 v[40:43], v[64:67], v[220:223], v[40:43]
L_cst6:
    s_waitcnt vmcnt(1)
    v_max3_u32 v2, v224, v225, v226
    v_max_u32 v2, v2, v227
    v_cmp_eq_u32 vcc, -1, v2
    s_nop 1
    s_cmp_eq_u64 vcc, 0
    s_cbranch_scc0 L_cbad6
L_cok6:
    s_waitcnt lgkmcnt(10)
    v_mfma_f32_16x16x32_bf16 v[24:27], v[68:71], v[224:227], v[24:27]
    v_mfma_f32_16x16x32_bf16 v[28:31], v[72:75], v[224:227], v[28:31]
    v_mfma_f32_16x16x32_bf16 v[32:35], v[76:79], v[224:227], v[32:35]
    v_mfma_f32_16x16x32_bf16 v[36:39], v[80:83], v[224:227], v[36:39]
    v_mfma_f32_16x16x32_bf16 v[40:43], v[84:87], v[224:227], v[40:43]
L_cst7:
    s_waitcnt vmcnt(0)
    v_max3_u32 v2, v228, v229, v230
    v_max_u32 v2, v2, v231
    v_cmp_eq_u32 vcc, -1, v2
    s_nop 1
    s_cmp_eq_u64 vcc, 0
    s_cbranch_scc0 L_cbad7
L_cok7:
    s_waitcnt lgkmcnt(0)
    v_mfma_f32_16x16x32_bf16 v[24:27], v[88:91], v[228:231], v[24:27]
    v_mfma_f32_16x16x32_bf16 v[28:31], v[92:95], v[228:231], v[28:31]
    v_mfma_f32_16x16x32_bf16 v[32:35], v[96:99], v[228:231], v[32:35]
    v_mfma_f32_16x16x32_bf16 v[36:39], v[100:103], v[228:231], v[36:39]
    v_mfma_f32_16x16x32_bf16 v[40:43], v[104:107], v[228:231], v[40:43]
    s_nop 7
    ds_write_b128 v241, v[36:39] offset:0
    ds_write_b128 v241, v[40:43] offset:1024
    s_waitcnt lgkmcnt(0)
    s_barrier
    ds_read_b128 v[168:171], v244 offset:0
    ds_read_b128 v[172:175], v244 offset:1024
    ds_read_b128 v[176:179], v244 offset:2048
    s_waitcnt lgkmcnt(2)
    v_add_f32 v24, v24, v168
    v_add_f32 v25, v25, v169
    v_add_f32 v26, v26, v170
    v_add_f32 v27, v27, v171
    v_cvt_pk_bf16_f32 v24, v24, v25
    v_cvt_pk_bf16_f32 v25, v26, v27
    buffer_store_dwordx2 v[24:25], v239, s[36:39], 0 offen offset:0
    s_waitcnt lgkmcnt(1)
    v_add_f32 v28, v28, v172
    v_add_f32 v29, v29, v173
    v_add_f32 v30, v30, v174
    v_add_f32 v31, v31, v175
    v_cvt_pk_bf16_f32 v28, v28, v29
    v_cvt_pk_bf16_f32 v29, v30, v31
    buffer_store_dwordx2 v[28:29], v239, s[36:39], 0 offen offset:32
    s_waitcnt lgkmcnt(0)
    v_add_f32 v32, v32, v176
    v_add_f32 v33, v33, v177
    v_add_f32 v34, v34, v178
    v_add_f32 v35, v35, v179
    v_cvt_pk_bf16_f32 v32, v32, v33
    v_cvt_pk_bf16_f32 v33, v34, v35
    buffer_store_dwordx2 v[32:33], v239, s[36:39], 0 offen offset:64
    s_endpgm
L_hook:
    s_cmp_eq_u32 s58, 0
    s_cbranch_scc0 L_hook3
    s_mov_b32 s59, 1600000
L_wb:
    ds_read_b32 v2, v8 offset:24
    s_waitcnt lgkmcnt(0)
    v_readfirstlane_b32 s56, v2
    s_nop 1
    s_cmp_eq_u32 s56, 1
    s_cbranch_scc0 L_wbs
L_wbd:
    s_branch L_hookr
L_hook3:
    s_mov_b32 s59, 1600000
L_wg:
    ds_read_b32 v2, v8 offset:28
    s_waitcnt lgkmcnt(0)
    v_readfirstlane_b32 s56, v2
    s_nop 1
    s_cmp_eq_u32 s56, 1
    s_cbranch_scc0 L_wgs
L_wgd:
    s_mov_b32 s30, 0
    s_add_u32 s40, s26, 0x49000
    s_addc_u32 s41, s27, 0
    s_and_b32 s41, s41, 0xffff
    s_mov_b32 s42, 0x4000
    s_mov_b32 s43, 0x20000
    v_bfe_u32 v2, v10, 4, 5
    v_lshlrev_b32 v2, 3, v2
    s_lshr_b32 s56, s51, 1
    buffer_load_dword v22, v2, s[40:43], s56 offen offset:4 sc1
    buffer_load_dword v23, v2, s[40:43], s56 offen offset:260 sc1
    s_add_u32 s40, s26, 0xa80000
    s_addc_u32 s41, s27, 0
    s_and_b32 s41, s41, 0xffff
    s_mov_b32 s42, 0x280000
    s_mov_b32 s43, 0x20000
    s_branch L_hookr
L_help:
    s_setprio 3
    s_and_b32 s56, s54, 3
    s_lshl_b32 s98, s53, 2
    s_add_u32 s98, s98, s56
    s_lshr_b32 s99, s54, 2
    v_and_b32 v2, 15, v1
    v_lshrrev_b32 v3, 4, v1
    v_and_b32 v6, 0x13, v2
    v_bfe_u32 v5, v2, 2, 1
    v_lshl_add_u32 v6, v5, 3, v6
    v_bfe_u32 v5, v2, 3, 1
    v_lshl_add_u32 v6, v5, 2, v6
    s_and_b32 s56, s52, 3
    s_lshl_b32 s56, s56, 4
    s_lshl_b32 s57, s98, 6
    s_add_u32 s56, s56, s57
    v_add_u32 v4, s56, v2
    s_and_b32 s56, s52, 1
    s_lshl_b32 s56, s56, 10
    s_and_b32 s57, s52, 2
    s_lshl_b32 s57, s57, 4
    s_add_u32 s56, s56, s57
    s_add_u32 s56, s56, s98
    v_lshl_add_u32 v2, v6, 6, s56
    v_mov_b32 v19, v2
    v_lshlrev_b32 v68, 3, v4
    v_lshlrev_b32 v12, 4, v4
    v_lshl_add_u32 v12, v3, 15, v12
    v_mul_u32_u24 v13, 1280, v2
    v_lshl_add_u32 v13, v3, 3, v13
    s_mul_i32 s56, s99, 160
    v_add_u32 v13, s56, v13
    v_lshrrev_b32 v4, 2, v1
    v_and_b32 v3, 3, v1
    v_mul_u32_u24 v10, 160, v4
    v_lshl_add_u32 v10, v3, 3, v10
    s_cmp_lt_u32 s99, 4
    s_cselect_b32 s56, 0, 3
    v_xor_b32 v3, s56, v3
    v_mul_u32_u24 v11, 176, v4
    v_lshl_add_u32 v11, v3, 3, v11
    v_add_u32 v11, 102400, v11
    s_and_b32 s56, s52, 3
    s_xor_b32 s56, s56, 2
    s_mul_i32 s56, s56, 6144
    s_add_u32 s56, s56, 131072
    v_lshl_add_u32 v14, v1, 4, s56
    v_add_u32 v15, 3072, v14
    v_mul_u32_u24 v4, 187, v1
    v_lshrrev_b32 v4, 11, v4
    v_mul_u32_u24 v5, 11, v4
    v_sub_u32 v5, v1, v5
    v_mul_u32_u24 v18, 21504, v4
    v_lshrrev_b32 v4, 1, v5
    v_lshl_add_u32 v18, v4, 10, v18
    v_and_b32 v5, 1, v5
    v_lshl_add_u32 v18, v5, 4, v18
    s_sub_u32 s56, 7, s99
    s_sub_u32 s57, 32, s98
    s_and_b32 s57, s57, 31
    s_cmp_lt_u32 s99, 4
    s_cselect_b32 s56, s99, s56
    s_cselect_b32 s57, s98, s57
    s_mul_i32 s56, s56, 5120
    s_lshl_b32 s57, s57, 5
    s_add_u32 s56, s56, s57
    v_add_u32 v18, s56, v18
    v_lshlrev_b32 v17, 4, v1
    v_cvt_f32_u32 v130, v19
    v_mul_f32 v130, 0x3a000000, v130
    v_cos_f32 v128, v130
    v_lshrrev_b32 v4, 4, v1
    v_add_f32 v128, v128, v128
    v_mov_b32 v129, v128
    v_lshl_add_u32 v88, v4, 3, 0
    v_lshl_add_u32 v108, v4, 3, 32
    v_cvt_f32_u32 v88, v88
    v_cvt_f32_u32 v108, v108
    v_mul_f32 v88, v88, v130
    v_mul_f32 v108, v108, v130
    v_fract_f32 v88, v88
    v_fract_f32 v108, v108
    v_add_f32 v90, v88, v130
    v_add_f32 v110, v108, v130
    v_sin_f32 v89, -v88
    v_sin_f32 v109, -v108
    v_cos_f32 v88, v88
    v_cos_f32 v108, v108
    v_sin_f32 v91, -v90
    v_sin_f32 v111, -v110
    v_cos_f32 v90, v90
    v_cos_f32 v110, v110
    v_pk_fma_f32 v[92:93], v[90:91], v[128:129], v[88:89] neg_lo:[0,0,1] neg_hi:[0,0,1]
    v_pk_fma_f32 v[112:113], v[110:111], v[128:129], v[108:109] neg_lo:[0,0,1] neg_hi:[0,0,1]
    v_pk_fma_f32 v[94:95], v[92:93], v[128:129], v[90:91] neg_lo:[0,0,1] neg_hi:[0,0,1]
    v_pk_fma_f32 v[114:115], v[112:113], v[128:129], v[110:111] neg_lo:[0,0,1] neg_hi:[0,0,1]
    v_pk_fma_f32 v[96:97], v[94:95], v[128:129], v[92:93] neg_lo:[0,0,1] neg_hi:[0,0,1]
    v_pk_fma_f32 v[116:117], v[114:115], v[128:129], v[112:113] neg_lo:[0,0,1] neg_hi:[0,0,1]
    v_pk_fma_f32 v[98:99], v[96:97], v[128:129], v[94:95] neg_lo:[0,0,1] neg_hi:[0,0,1]
    v_pk_fma_f32 v[118:119], v[116:117], v[128:129], v[114:115] neg_lo:[0,0,1] neg_hi:[0,0,1]
    v_pk_fma_f32 v[100:101], v[98:99], v[128:129], v[96:97] neg_lo:[0,0,1] neg_hi:[0,0,1]
    v_pk_fma_f32 v[120:121], v[118:119], v[128:129], v[116:117] neg_lo:[0,0,1] neg_hi:[0,0,1]
    v_pk_fma_f32 v[102:103], v[100:101], v[128:129], v[98:99] neg_lo:[0,0,1] neg_hi:[0,0,1]
    v_pk_fma_f32 v[122:123], v[120:121], v[128:129], v[118:119] neg_lo:[0,0,1] neg_hi:[0,0,1]
    v_cvt_pk_bf16_f32 v40, v88, v90
    v_cvt_pk_bf16_f32 v44, v108, v110
    v_cvt_pk_bf16_f32 v41, v92, v94
    v_cvt_pk_bf16_f32 v45, v112, v114
    v_cvt_pk_bf16_f32 v42, v96, v98
    v_cvt_pk_bf16_f32 v46, v116, v118
    v_cvt_pk_bf16_f32 v43, v100, v102
    v_cvt_pk_bf16_f32 v47, v120, v122
    v_cvt_pk_bf16_f32 v48, v89, v91
    v_cvt_pk_bf16_f32 v52, v109, v111
    v_cvt_pk_bf16_f32 v49, v93, v95
    v_cvt_pk_bf16_f32 v53, v113, v115
    v_cvt_pk_bf16_f32 v50, v97, v99
    v_cvt_pk_bf16_f32 v54, v117, v119
    v_cvt_pk_bf16_f32 v51, v101, v103
    v_cvt_pk_bf16_f32 v55, v121, v123
    s_call_b64 s[62:63], L_p2sub
    s_mov_b32 s59, 1600000
L_hb:
    ds_read_b32 v2, v8 offset:24
    s_waitcnt lgkmcnt(0)
    v_readfirstlane_b32 s56, v2
    s_nop 1
    s_cmp_eq_u32 s56, 1
    s_cbranch_scc0 L_hbs
L_hbd:
    s_setprio 0
    s_cmp_eq_u32 s25, 0
    s_cbranch_scc1 L_hg
    s_cmp_ge_u32 s54, 20
    s_cbranch_scc1 L_hg1
    s_add_u32 s36, s26, 0x7e0000
    s_addc_u32 s37, s27, 0
    s_and_b32 s37, s37, 0xffff
    s_mov_b32 s38, 0x2a0000
    s_mov_b32 s39, 0x20000
    s_mov_b32 s57, 1376256
    buffer_store_dwordx4 v[232:235], v9, s[36:39], 0 offen offset:0 sc1
    buffer_store_dwordx4 v[236:239], v9, s[36:39], 0 offen offset:1024 sc1
    buffer_store_dwordx4 v[240:243], v9, s[36:39], s57 offen offset:0 sc1
    buffer_store_dwordx4 v[244:247], v9, s[36:39], s57 offen offset:1024 sc1
    s_or_b32 s56, s53, s54
    s_cmp_ge_u32 s56, 4
    s_cbranch_scc1 L_gs1
    v_add_u32 v9, 20480, v9
    s_mov_b64 exec, s[60:61]
    buffer_store_dwordx4 v[248:251], v9, s[36:39], 0 offen sc1
    buffer_store_dwordx4 v[252:255], v9, s[36:39], s57 offen sc1
    s_mov_b64 exec, -1
L_gs1:
L_hg1:
    s_waitcnt vmcnt(0)
    v_mov_b32 v2, 0
    v_mov_b32 v3, s55
    s_mov_b64 exec, 1
    buffer_store_dword v3, v2, s[44:47], s25 offen sc1
    s_mov_b64 exec, -1
L_hg:
    s_mov_b32 s59, 1600000
L_hr:
    ds_read_b32 v2, v8 offset:8
    s_waitcnt lgkmcnt(0)
    v_readfirstlane_b32 s56, v2
    s_nop 1
    s_cmp_eq_u32 s56, 8
    s_cbranch_scc0 L_hrs
L_hrd:
    s_mul_i32 s56, s99, 102400
    s_add_u32 s56, s56, 13631488
    s_add_u32 s40, s26, s56
    s_addc_u32 s41, s27, 0
    s_and_b32 s41, s41, 0xffff
    s_mov_b32 s42, 0x19000
    s_mov_b32 s43, 0x20000
    s_and_b32 s3, s52, 3
    s_lshl_b32 s3, s3, 10
L_hwo:
    s_mov_b32 m0, s3
    s_waitcnt vmcnt(1)
    buffer_load_dwordx4 v17, s[40:43], s3 offen lds
    s_add_u32 s3, s3, 4096
    s_cmp_lt_u32 s3, 102400
    s_cbranch_scc1 L_hwo
    s_cmp_lg_u32 s52, 4
    s_cbranch_scc1 L_hpg
    s_setprio 3
    s_cmp_lg_u32 s2, 0
    s_cbranch_scc1 L_ed
    v_lshlrev_b32 v2, 9, v1
    s_mov_b32 s57, 4096
    s_mov_b32 s59, 200000
L_pe:
    buffer_load_dword v4, v2, s[44:47], s57 offen offset:0 sc1
    buffer_load_dword v5, v2, s[44:47], s57 offen offset:128 sc1
    buffer_load_dword v6, v2, s[44:47], s57 offen offset:256 sc1
    buffer_load_dword v7, v2, s[44:47], s57 offen offset:384 sc1
    s_waitcnt vmcnt(0)
    v_xor_b32 v4, s55, v4
    v_xor_b32 v5, s55, v5
    v_xor_b32 v6, s55, v6
    v_xor_b32 v7, s55, v7
    v_or3_b32 v4, v4, v5, v6
    v_or_b32 v4, v4, v7
    v_cmp_ne_u32 vcc, 0, v4
    s_nop 1
    s_cmp_eq_u64 vcc, 0
    s_cbranch_scc1 L_ped
    s_sleep 2
    s_sub_u32 s59, s59, 1
    s_cmp_lg_u32 s59, 0
    s_cbranch_scc1 L_pe
L_ped:
    v_mov_b32 v2, 0
    v_mov_b32 v3, s55
    s_mov_b64 exec, 1
    buffer_store_dword v3, v2, s[44:47], 0 offen sc1
    s_mov_b64 exec, -1
L_ed:
    s_mov_b32 s59, 200000
L_pg:
    v_mul_u32_u24 v2, 48, v1
    buffer_load_dwordx4 v[56:59], v2, s[44:47], 0 offen offset:1024 sc1
    buffer_load_dwordx4 v[60:63], v2, s[44:47], 0 offen offset:1040 sc1
    buffer_load_dwordx2 v[64:65], v2, s[44:47], 0 offen offset:1056 sc1
    v_lshlrev_b32 v2, 2, v1
    s_mov_b32 s56, 53504
    buffer_load_dword v66, v2, s[44:47], s56 offen sc1
    s_mov_b32 s56, 34816
    v_and_b32 v2, 15, v1
    v_lshlrev_b32 v2, 7, v2
    buffer_load_dword v67, v2, s[44:47], s56 offen sc1
    s_waitcnt vmcnt(0)
    v_xor_b32 v56, s55, v56
    v_xor_b32 v57, s55, v57
    v_xor_b32 v58, s55, v58
    v_xor_b32 v59, s55, v59
    v_xor_b32 v60, s55, v60
    v_xor_b32 v61, s55, v61
    v_xor_b32 v62, s55, v62
    v_xor_b32 v63, s55, v63
    v_xor_b32 v64, s55, v64
    v_xor_b32 v65, s55, v65
    v_xor_b32 v66, s55, v66
    v_xor_b32 v67, s55, v67
    v_or3_b32 v56, v56, v57, v58
    v_or3_b32 v56, v56, v59, v60
    v_or3_b32 v56, v56, v61, v62
    v_or3_b32 v56, v56, v63, v64
    v_or3_b32 v56, v56, v65, v66
    v_or_b32 v56, v56, v67
    v_cmp_ne_u32 vcc, 0, v56
    s_nop 1
    s_cmp_eq_u64 vcc, 0
    s_cbranch_scc1 L_pgd
    s_sleep 16
    s_sub_u32 s59, s59, 1
    s_cmp_lg_u32 s59, 0
    s_cbranch_scc1 L_pg
L_pgd:
    v_mov_b32 v2, 1
    ds_write_b32 v8, v2 offset:28
    s_setprio 0
L_hpg:
    s_mov_b32 s59, 1600000
L_hq:
    ds_read_b32 v2, v8 offset:28
    s_waitcnt lgkmcnt(0)
    v_readfirstlane_b32 s56, v2
    s_nop 1
    s_cmp_eq_u32 s56, 1
    s_cbranch_scc0 L_hqs
L_hqd:
    s_add_u32 s40, s26, 0x49000
    s_addc_u32 s41, s27, 0
    s_and_b32 s41, s41, 0xffff
    s_mov_b32 s42, 0x4000
    s_mov_b32 s43, 0x20000
    buffer_load_dword v16, v68, s[40:43], 0 offen sc1
    s_add_u32 s40, s26, 0x7e0000
    s_addc_u32 s41, s27, 0
    s_and_b32 s41, s41, 0xffff
    s_mov_b32 s42, 0x2a0000
    s_mov_b32 s43, 0x20000
    s_and_b32 s57, s52, 3
    s_mul_i32 s3, s57, 704
    s_mul_i32 s57, s57, 172032
    s_mov_b32 exec_hi, 0xfff
    s_add_u32 m0, s3, 102400
    s_add_u32 s56, s57, 0
    s_waitcnt vmcnt(1)
    buffer_load_dwordx4 v18, s[40:43], s56 offen lds
    s_add_u32 m0, s3, 105216
    s_add_u32 s56, s57, 86016
    s_waitcnt vmcnt(1)
    buffer_load_dwordx4 v18, s[40:43], s56 offen lds
    s_add_u32 m0, s3, 108032
    s_add_u32 s56, s57, 688128
    s_waitcnt vmcnt(1)
    buffer_load_dwordx4 v18, s[40:43], s56 offen lds
    s_add_u32 m0, s3, 110848
    s_add_u32 s56, s57, 774144
    s_waitcnt vmcnt(1)
    buffer_load_dwordx4 v18, s[40:43], s56 offen lds
    s_add_u32 m0, s3, 113664
    s_add_u32 s56, s57, 1376256
    s_waitcnt vmcnt(1)
    buffer_load_dwordx4 v18, s[40:43], s56 offen lds
    s_add_u32 m0, s3, 116480
    s_add_u32 s56, s57, 1462272
    s_waitcnt vmcnt(1)
    buffer_load_dwordx4 v18, s[40:43], s56 offen lds
    s_add_u32 m0, s3, 119296
    s_add_u32 s56, s57, 2064384
    s_waitcnt vmcnt(1)
    buffer_load_dwordx4 v18, s[40:43], s56 offen lds
    s_add_u32 m0, s3, 122112
    s_add_u32 s56, s57, 2150400
    s_waitcnt vmcnt(1)
    buffer_load_dwordx4 v18, s[40:43], s56 offen lds
    s_mov_b64 exec, -1
    s_waitcnt vmcnt(0)
    v_mov_b32 v2, 1
    s_mov_b64 exec, 1
    ds_add_u32 v8, v2 offset:48
    s_mov_b64 exec, -1
    s_mov_b32 s59, 1600000
L_hi:
    ds_read_b32 v2, v8 offset:48
    s_waitcnt lgkmcnt(0)
    v_readfirstlane_b32 s56, v2
    s_nop 1
    s_cmp_eq_u32 s56, 4
    s_cbranch_scc0 L_his
L_hid:
    s_setprio 0
    s_cmp_lt_u32 s99, 4
    s_cbranch_scc0 L_ymir
    ds_read_b64_tr_b16 v[88:89], v11 offset:0
    ds_read_b64_tr_b16 v[90:91], v11 offset:2816
    ds_read_b64_tr_b16 v[92:93], v11 offset:32
    ds_read_b64_tr_b16 v[94:95], v11 offset:2848
    ds_read_b64_tr_b16 v[96:97], v11 offset:64
    ds_read_b64_tr_b16 v[98:99], v11 offset:2880
    ds_read_b64_tr_b16 v[100:101], v11 offset:96
    ds_read_b64_tr_b16 v[102:103], v11 offset:2912
    ds_read_b64_tr_b16 v[104:105], v11 offset:128
    ds_read_b64_tr_b16 v[106:107], v11 offset:2944
    ds_read_b64_tr_b16 v[108:109], v11 offset:5632
    ds_read_b64_tr_b16 v[110:111], v11 offset:8448
    ds_read_b64_tr_b16 v[112:113], v11 offset:5664
    ds_read_b64_tr_b16 v[114:115], v11 offset:8480
    ds_read_b64_tr_b16 v[116:117], v11 offset:5696
    ds_read_b64_tr_b16 v[118:119], v11 offset:8512
    ds_read_b64_tr_b16 v[120:121], v11 offset:5728
    ds_read_b64_tr_b16 v[122:123], v11 offset:8544
    ds_read_b64_tr_b16 v[124:125], v11 offset:5760
    ds_read_b64_tr_b16 v[126:127], v11 offset:8576
    ds_read_b64_tr_b16 v[128:129], v11 offset:11264
    ds_read_b64_tr_b16 v[130:131], v11 offset:14080
    ds_read_b64_tr_b16 v[132:133], v11 offset:11296
    ds_read_b64_tr_b16 v[134:135], v11 offset:14112
    ds_read_b64_tr_b16 v[136:137], v11 offset:11328
    ds_read_b64_tr_b16 v[138:139], v11 offset:14144
    ds_read_b64_tr_b16 v[140:141], v11 offset:11360
    ds_read_b64_tr_b16 v[142:143], v11 offset:14176
    ds_read_b64_tr_b16 v[144:145], v11 offset:11392
    ds_read_b64_tr_b16 v[146:147], v11 offset:14208
    ds_read_b64_tr_b16 v[148:149], v11 offset:16896
    ds_read_b64_tr_b16 v[150:151], v11 offset:19712
    ds_read_b64_tr_b16 v[152:153], v11 offset:16928
    ds_read_b64_tr_b16 v[154:155], v11 offset:19744
    ds_read_b64_tr_b16 v[156:157], v11 offset:16960
    ds_read_b64_tr_b16 v[158:159], v11 offset:19776
    ds_read_b64_tr_b16 v[160:161], v11 offset:16992
    ds_read_b64_tr_b16 v[162:163], v11 offset:19808
    ds_read_b64_tr_b16 v[164:165], v11 offset:17024
    ds_read_b64_tr_b16 v[166:167], v11 offset:19840
    s_waitcnt lgkmcnt(15)
    v_mfma_f32_16x16x32_bf16 v[20:23], v[88:91], v[40:43], 0
    v_mfma_f32_16x16x32_bf16 v[24:27], v[92:95], v[40:43], 0
    v_mfma_f32_16x16x32_bf16 v[28:31], v[96:99], v[40:43], 0
    v_mfma_f32_16x16x32_bf16 v[32:35], v[100:103], v[40:43], 0
    v_mfma_f32_16x16x32_bf16 v[36:39], v[104:107], v[40:43], 0
    s_waitcnt lgkmcnt(15)
    v_mfma_f32_16x16x32_bf16 v[20:23], v[108:111], v[44:47], v[20:23]
    v_mfma_f32_16x16x32_bf16 v[24:27], v[112:115], v[44:47], v[24:27]
    v_mfma_f32_16x16x32_bf16 v[28:31], v[116:119], v[44:47], v[28:31]
    v_mfma_f32_16x16x32_bf16 v[32:35], v[120:123], v[44:47], v[32:35]
    v_mfma_f32_16x16x32_bf16 v[36:39], v[124:127], v[44:47], v[36:39]
    s_waitcnt lgkmcnt(10)
    v_mfma_f32_16x16x32_bf16 v[20:23], v[128:131], v[48:51], v[20:23]
    v_mfma_f32_16x16x32_bf16 v[24:27], v[132:135], v[48:51], v[24:27]
    v_mfma_f32_16x16x32_bf16 v[28:31], v[136:139], v[48:51], v[28:31]
    v_mfma_f32_16x16x32_bf16 v[32:35], v[140:143], v[48:51], v[32:35]
    v_mfma_f32_16x16x32_bf16 v[36:39], v[144:147], v[48:51], v[36:39]
    s_waitcnt lgkmcnt(0)
    v_mfma_f32_16x16x32_bf16 v[20:23], v[148:151], v[52:55], v[20:23]
    v_mfma_f32_16x16x32_bf16 v[24:27], v[152:155], v[52:55], v[24:27]
    v_mfma_f32_16x16x32_bf16 v[28:31], v[156:159], v[52:55], v[28:31]
    v_mfma_f32_16x16x32_bf16 v[32:35], v[160:163], v[52:55], v[32:35]
    v_mfma_f32_16x16x32_bf16 v[36:39], v[164:167], v[52:55], v[36:39]
    s_nop 7
    v_pk_mul_f32 v[20:21], v[20:21], v[16:17] op_sel_hi:[1,0]
    v_pk_mul_f32 v[22:23], v[22:23], v[16:17] op_sel_hi:[1,0]
    v_pk_mul_f32 v[24:25], v[24:25], v[16:17] op_sel_hi:[1,0]
    v_pk_mul_f32 v[26:27], v[26:27], v[16:17] op_sel_hi:[1,0]
    v_pk_mul_f32 v[28:29], v[28:29], v[16:17] op_sel_hi:[1,0]
    v_pk_mul_f32 v[30:31], v[30:31], v[16:17] op_sel_hi:[1,0]
    v_pk_mul_f32 v[32:33], v[32:33], v[16:17] op_sel_hi:[1,0]
    v_pk_mul_f32 v[34:35], v[34:35], v[16:17] op_sel_hi:[1,0]
    v_pk_mul_f32 v[36:37], v[36:37], v[16:17] op_sel_hi:[1,0]
    v_pk_mul_f32 v[38:39], v[38:39], v[16:17] op_sel_hi:[1,0]
    s_branch L_ydone
L_ymir:
    v_xor_b32 v48, 0x80008000, v48
    v_xor_b32 v49, 0x80008000, v49
    v_xor_b32 v50, 0x80008000, v50
    v_xor_b32 v51, 0x80008000, v51
    v_xor_b32 v52, 0x80008000, v52
    v_xor_b32 v53, 0x80008000, v53
    v_xor_b32 v54, 0x80008000, v54
    v_xor_b32 v55, 0x80008000, v55
    ds_read_b64_tr_b16 v[188:189], v11 offset:160
    ds_read_b64_tr_b16 v[190:191], v11 offset:2976
    ds_read_b64_tr_b16 v[192:193], v11 offset:5792
    ds_read_b64_tr_b16 v[194:195], v11 offset:8608
    ds_read_b64_tr_b16 v[196:197], v11 offset:11424
    ds_read_b64_tr_b16 v[198:199], v11 offset:14240
    ds_read_b64_tr_b16 v[200:201], v11 offset:17056
    ds_read_b64_tr_b16 v[202:203], v11 offset:19872
    v_add_u32 v2, 48, v1
    v_lshlrev_b32 v2, 2, v2
    s_waitcnt lgkmcnt(0)
    v_mfma_f32_16x16x32_bf16 v[208:211], v[188:191], v[40:43], 0
    v_mfma_f32_16x16x32_bf16 v[208:211], v[192:195], v[44:47], v[208:211]
    v_mfma_f32_16x16x32_bf16 v[208:211], v[196:199], v[48:51], v[208:211]
    v_mfma_f32_16x16x32_bf16 v[208:211], v[200:203], v[52:55], v[208:211]
    ds_read_b64_tr_b16 v[88:89], v11 offset:0
    ds_read_b64_tr_b16 v[90:91], v11 offset:2816
    ds_read_b64_tr_b16 v[92:93], v11 offset:32
    ds_read_b64_tr_b16 v[94:95], v11 offset:2848
    ds_read_b64_tr_b16 v[96:97], v11 offset:64
    ds_read_b64_tr_b16 v[98:99], v11 offset:2880
    ds_read_b64_tr_b16 v[100:101], v11 offset:96
    ds_read_b64_tr_b16 v[102:103], v11 offset:2912
    ds_read_b64_tr_b16 v[104:105], v11 offset:128
    ds_read_b64_tr_b16 v[106:107], v11 offset:2944
    ds_read_b64_tr_b16 v[108:109], v11 offset:5632
    ds_read_b64_tr_b16 v[110:111], v11 offset:8448
    ds_read_b64_tr_b16 v[112:113], v11 offset:5664
    ds_read_b64_tr_b16 v[114:115], v11 offset:8480
    ds_read_b64_tr_b16 v[116:117], v11 offset:5696
    ds_read_b64_tr_b16 v[118:119], v11 offset:8512
    ds_read_b64_tr_b16 v[120:121], v11 offset:5728
    ds_read_b64_tr_b16 v[122:123], v11 offset:8544
    ds_read_b64_tr_b16 v[124:125], v11 offset:5760
    ds_read_b64_tr_b16 v[126:127], v11 offset:8576
    ds_read_b64_tr_b16 v[128:129], v11 offset:11264
    ds_read_b64_tr_b16 v[130:131], v11 offset:14080
    ds_read_b64_tr_b16 v[132:133], v11 offset:11296
    ds_read_b64_tr_b16 v[134:135], v11 offset:14112
    ds_read_b64_tr_b16 v[136:137], v11 offset:11328
    ds_read_b64_tr_b16 v[138:139], v11 offset:14144
    ds_read_b64_tr_b16 v[140:141], v11 offset:11360
    ds_read_b64_tr_b16 v[142:143], v11 offset:14176
    ds_read_b64_tr_b16 v[144:145], v11 offset:11392
    ds_read_b64_tr_b16 v[146:147], v11 offset:14208
    ds_read_b64_tr_b16 v[148:149], v11 offset:16896
    ds_read_b64_tr_b16 v[150:151], v11 offset:19712
    ds_read_b64_tr_b16 v[152:153], v11 offset:16928
    ds_read_b64_tr_b16 v[154:155], v11 offset:19744
    ds_read_b64_tr_b16 v[156:157], v11 offset:16960
    ds_read_b64_tr_b16 v[158:159], v11 offset:19776
    ds_read_b64_tr_b16 v[160:161], v11 offset:16992
    ds_read_b64_tr_b16 v[162:163], v11 offset:19808
    ds_read_b64_tr_b16 v[164:165], v11 offset:17024
    ds_read_b64_tr_b16 v[166:167], v11 offset:19840
    s_waitcnt lgkmcnt(15)
    v_mfma_f32_16x16x32_bf16 v[20:23], v[88:91], v[40:43], 0
    v_mfma_f32_16x16x32_bf16 v[24:27], v[92:95], v[40:43], 0
    v_mfma_f32_16x16x32_bf16 v[28:31], v[96:99], v[40:43], 0
    v_mfma_f32_16x16x32_bf16 v[32:35], v[100:103], v[40:43], 0
    v_mfma_f32_16x16x32_bf16 v[36:39], v[104:107], v[40:43], 0
    s_waitcnt lgkmcnt(15)
    v_mfma_f32_16x16x32_bf16 v[20:23], v[108:111], v[44:47], v[20:23]
    v_mfma_f32_16x16x32_bf16 v[24:27], v[112:115], v[44:47], v[24:27]
    v_mfma_f32_16x16x32_bf16 v[28:31], v[116:119], v[44:47], v[28:31]
    v_mfma_f32_16x16x32_bf16 v[32:35], v[120:123], v[44:47], v[32:35]
    v_mfma_f32_16x16x32_bf16 v[36:39], v[124:127], v[44:47], v[36:39]
    s_waitcnt lgkmcnt(10)
    v_mfma_f32_16x16x32_bf16 v[20:23], v[128:131], v[48:51], v[20:23]
    v_mfma_f32_16x16x32_bf16 v[24:27], v[132:135], v[48:51], v[24:27]
    v_mfma_f32_16x16x32_bf16 v[28:31], v[136:139], v[48:51], v[28:31]
    v_mfma_f32_16x16x32_bf16 v[32:35], v[140:143], v[48:51], v[32:35]
    v_mfma_f32_16x16x32_bf16 v[36:39], v[144:147], v[48:51], v[36:39]
    s_waitcnt lgkmcnt(0)
    v_mfma_f32_16x16x32_bf16 v[20:23], v[148:151], v[52:55], v[20:23]
    v_mfma_f32_16x16x32_bf16 v[24:27], v[152:155], v[52:55], v[24:27]
    v_mfma_f32_16x16x32_bf16 v[28:31], v[156:159], v[52:55], v[28:31]
    v_mfma_f32_16x16x32_bf16 v[32:35], v[160:163], v[52:55], v[32:35]
    v_mfma_f32_16x16x32_bf16 v[36:39], v[164:167], v[52:55], v[36:39]
    s_nop 7
    s_mov_b32 exec_lo, 0
    s_mov_b32 exec_hi, 0xffff0000
    v_mov_b32 v20, v24
    v_mov_b32 v24, v28
    v_mov_b32 v28, v32
    v_mov_b32 v32, v36
    v_mov_b32 v36, v208
    s_mov_b64 exec, -1
    ds_bpermute_b32 v168, v2, v36
    ds_bpermute_b32 v172, v2, v32
    ds_bpermute_b32 v176, v2, v28
    ds_bpermute_b32 v180, v2, v24
    ds_bpermute_b32 v184, v2, v20
    v_mul_f32 v169, v39, v16
    v_mul_f32 v170, v38, v16
    v_mul_f32 v171, v37, v16
    v_mul_f32 v173, v35, v16
    v_mul_f32 v174, v34, v16
    v_mul_f32 v175, v33, v16
    v_mul_f32 v177, v31, v16
    v_mul_f32 v178, v30, v16
    v_mul_f32 v179, v29, v16
    v_mul_f32 v181, v27, v16
    v_mul_f32 v182, v26, v16
    v_mul_f32 v183, v25, v16
    v_mul_f32 v185, v23, v16
    v_mul_f32 v186, v22, v16
    v_mul_f32 v187, v21, v16
    s_waitcnt lgkmcnt(0)
    v_mul_f32 v168, v168, v16
    v_mul_f32 v172, v172, v16
    v_mul_f32 v176, v176, v16
    v_mul_f32 v180, v180, v16
    v_mul_f32 v184, v184, v16
    v_mov_b64 v[20:21], v[168:169]
    v_mov_b64 v[22:23], v[170:171]
    v_mov_b64 v[24:25], v[172:173]
    v_mov_b64 v[26:27], v[174:175]
    v_mov_b64 v[28:29], v[176:177]
    v_mov_b64 v[30:31], v[178:179]
    v_mov_b64 v[32:33], v[180:181]
    v_mov_b64 v[34:35], v[182:183]
    v_mov_b64 v[36:37], v[184:185]
    v_mov_b64 v[38:39], v[186:187]
L_ydone:
    ds_read_b64_tr_b16 v[88:89], v10 offset:0
    ds_read_b64_tr_b16 v[90:91], v10 offset:2560
    ds_read_b64_tr_b16 v[92:93], v10 offset:32
    ds_read_b64_tr_b16 v[94:95], v10 offset:2592
    ds_read_b64_tr_b16 v[96:97], v10 offset:64
    ds_read_b64_tr_b16 v[98:99], v10 offset:2624
    ds_read_b64_tr_b16 v[100:101], v10 offset:96
    ds_read_b64_tr_b16 v[102:103], v10 offset:2656
    ds_read_b64_tr_b16 v[104:105], v10 offset:128
    ds_read_b64_tr_b16 v[106:107], v10 offset:2688
    ds_read_b64_tr_b16 v[108:109], v10 offset:5120
    ds_read_b64_tr_b16 v[110:111], v10 offset:7680
    ds_read_b64_tr_b16 v[112:113], v10 offset:5152
    ds_read_b64_tr_b16 v[114:115], v10 offset:7712
    ds_read_b64_tr_b16 v[116:117], v10 offset:5184
    ds_read_b64_tr_b16 v[118:119], v10 offset:7744
    ds_read_b64_tr_b16 v[120:121], v10 offset:5216
    ds_read_b64_tr_b16 v[122:123], v10 offset:7776
    ds_read_b64_tr_b16 v[124:125], v10 offset:5248
    ds_read_b64_tr_b16 v[126:127], v10 offset:7808
    ds_read_b64_tr_b16 v[128:129], v10 offset:10240
    ds_read_b64_tr_b16 v[130:131], v10 offset:12800
    ds_read_b64_tr_b16 v[132:133], v10 offset:10272
    ds_read_b64_tr_b16 v[134:135], v10 offset:12832
    ds_read_b64_tr_b16 v[136:137], v10 offset:10304
    ds_read_b64_tr_b16 v[138:139], v10 offset:12864
    ds_read_b64_tr_b16 v[140:141], v10 offset:10336
    ds_read_b64_tr_b16 v[142:143], v10 offset:12896
    ds_read_b64_tr_b16 v[144:145], v10 offset:10368
    ds_read_b64_tr_b16 v[146:147], v10 offset:12928
    ds_read_b64_tr_b16 v[148:149], v10 offset:15360
    ds_read_b64_tr_b16 v[150:151], v10 offset:17920
    ds_read_b64_tr_b16 v[152:153], v10 offset:15392
    ds_read_b64_tr_b16 v[154:155], v10 offset:17952
    ds_read_b64_tr_b16 v[156:157], v10 offset:15424
    ds_read_b64_tr_b16 v[158:159], v10 offset:17984
    ds_read_b64_tr_b16 v[160:161], v10 offset:15456
    ds_read_b64_tr_b16 v[162:163], v10 offset:18016
    ds_read_b64_tr_b16 v[164:165], v10 offset:15488
    ds_read_b64_tr_b16 v[166:167], v10 offset:18048
    ds_read_b64_tr_b16 v[168:169], v10 offset:20480
    ds_read_b64_tr_b16 v[170:171], v10 offset:23040
    ds_read_b64_tr_b16 v[172:173], v10 offset:20512
    ds_read_b64_tr_b16 v[174:175], v10 offset:23072
    ds_read_b64_tr_b16 v[176:177], v10 offset:20544
    ds_read_b64_tr_b16 v[178:179], v10 offset:23104
    ds_read_b64_tr_b16 v[180:181], v10 offset:20576
    ds_read_b64_tr_b16 v[182:183], v10 offset:23136
    ds_read_b64_tr_b16 v[184:185], v10 offset:20608
    ds_read_b64_tr_b16 v[186:187], v10 offset:23168
    ds_read_b64_tr_b16 v[188:189], v10 offset:25600
    ds_read_b64_tr_b16 v[190:191], v10 offset:28160
    ds_read_b64_tr_b16 v[192:193], v10 offset:25632
    ds_read_b64_tr_b16 v[194:195], v10 offset:28192
    ds_read_b64_tr_b16 v[196:197], v10 offset:25664
    ds_read_b64_tr_b16 v[198:199], v10 offset:28224
    ds_read_b64_tr_b16 v[200:201], v10 offset:25696
    ds_read_b64_tr_b16 v[202:203], v10 offset:28256
    ds_read_b64_tr_b16 v[204:205], v10 offset:25728
    ds_read_b64_tr_b16 v[206:207], v10 offset:28288
    ds_read_b64_tr_b16 v[208:209], v10 offset:30720
    ds_read_b64_tr_b16 v[210:211], v10 offset:33280
    ds_read_b64_tr_b16 v[212:213], v10 offset:30752
    ds_read_b64_tr_b16 v[214:215], v10 offset:33312
    ds_read_b64_tr_b16 v[216:217], v10 offset:30784
    ds_read_b64_tr_b16 v[218:219], v10 offset:33344
    ds_read_b64_tr_b16 v[220:221], v10 offset:30816
    ds_read_b64_tr_b16 v[222:223], v10 offset:33376
    ds_read_b64_tr_b16 v[224:225], v10 offset:30848
    ds_read_b64_tr_b16 v[226:227], v10 offset:33408
    ds_read_b64_tr_b16 v[228:229], v10 offset:35840
    ds_read_b64_tr_b16 v[230:231], v10 offset:38400
    ds_read_b64_tr_b16 v[232:233], v10 offset:35872
    ds_read_b64_tr_b16 v[234:235], v10 offset:38432
    ds_read_b64_tr_b16 v[236:237], v10 offset:35904
    ds_read_b64_tr_b16 v[238:239], v10 offset:38464
    ds_read_b64_tr_b16 v[240:241], v10 offset:35936
    ds_read_b64_tr_b16 v[242:243], v10 offset:38496
    ds_read_b64_tr_b16 v[244:245], v10 offset:35968
    ds_read_b64_tr_b16 v[246:247], v10 offset:38528
    s_add_u32 s40, s26, 0xa80000
    s_addc_u32 s41, s27, 0
    s_and_b32 s41, s41, 0xffff
    s_mov_b32 s42, 0x280000
    s_mov_b32 s43, 0x20000
    s_waitcnt lgkmcnt(0)
    s_barrier
    s_setprio 3
    s_mov_b32 s56, 0
    buffer_load_dwordx4 v[40:43], v12, s[40:43], s56 offen sc1
    s_mov_b32 s56, 131072
    buffer_load_dwordx4 v[44:47], v12, s[40:43], s56 offen sc1
    s_mov_b32 s56, 262144
    buffer_load_dwordx4 v[48:51], v12, s[40:43], s56 offen sc1
    s_mov_b32 s56, 393216
    buffer_load_dwordx4 v[52:55], v12, s[40:43], s56 offen sc1
    s_mov_b32 s36, s22
    s_and_b32 s37, s23, 0xffff
    s_mov_b32 s38, 0x280000
    s_mov_b32 s39, 0x20000
    s_mov_b32 s59, 200000
L_hst0:
    s_waitcnt vmcnt(3)
    v_max3_u32 v2, v40, v41, v42
    v_max_u32 v2, v2, v43
    v_cmp_eq_u32 vcc, -1, v2
    s_nop 1
    s_cmp_eq_u64 vcc, 0
    s_cbranch_scc0 L_hbad0
L_hok0:
    s_mov_b32 s56, 524288
    buffer_load_dwordx4 v[56:59], v12, s[40:43], s56 offen sc1
    s_waitcnt lgkmcnt(15)
    v_mfma_f32_16x16x32_bf16 v[20:23], v[88:91], v[40:43], v[20:23]
    v_mfma_f32_16x16x32_bf16 v[24:27], v[92:95], v[40:43], v[24:27]
    v_mfma_f32_16x16x32_bf16 v[28:31], v[96:99], v[40:43], v[28:31]
    v_mfma_f32_16x16x32_bf16 v[32:35], v[100:103], v[40:43], v[32:35]
    v_mfma_f32_16x16x32_bf16 v[36:39], v[104:107], v[40:43], v[36:39]
    ds_read_b64_tr_b16 v[88:89], v10 offset:40960
    ds_read_b64_tr_b16 v[90:91], v10 offset:43520
    ds_read_b64_tr_b16 v[92:93], v10 offset:40992
    ds_read_b64_tr_b16 v[94:95], v10 offset:43552
    ds_read_b64_tr_b16 v[96:97], v10 offset:41024
    ds_read_b64_tr_b16 v[98:99], v10 offset:43584
    ds_read_b64_tr_b16 v[100:101], v10 offset:41056
    ds_read_b64_tr_b16 v[102:103], v10 offset:43616
    ds_read_b64_tr_b16 v[104:105], v10 offset:41088
    ds_read_b64_tr_b16 v[106:107], v10 offset:43648
L_hst1:
    s_waitcnt vmcnt(3)
    v_max3_u32 v2, v44, v45, v46
    v_max_u32 v2, v2, v47
    v_cmp_eq_u32 vcc, -1, v2
    s_nop 1
    s_cmp_eq_u64 vcc, 0
    s_cbranch_scc0 L_hbad1
L_hok1:
    s_mov_b32 s56, 655360
    buffer_load_dwordx4 v[60:63], v12, s[40:43], s56 offen sc1
    s_waitcnt lgkmcnt(15)
    v_mfma_f32_16x16x32_bf16 v[20:23], v[108:111], v[44:47], v[20:23]
    v_mfma_f32_16x16x32_bf16 v[24:27], v[112:115], v[44:47], v[24:27]
    v_mfma_f32_16x16x32_bf16 v[28:31], v[116:119], v[44:47], v[28:31]
    v_mfma_f32_16x16x32_bf16 v[32:35], v[120:123], v[44:47], v[32:35]
    v_mfma_f32_16x16x32_bf16 v[36:39], v[124:127], v[44:47], v[36:39]
    ds_read_b64_tr_b16 v[108:109], v10 offset:46080
    ds_read_b64_tr_b16 v[110:111], v10 offset:48640
    ds_read_b64_tr_b16 v[112:113], v10 offset:46112
    ds_read_b64_tr_b16 v[114:115], v10 offset:48672
    ds_read_b64_tr_b16 v[116:117], v10 offset:46144
    ds_read_b64_tr_b16 v[118:119], v10 offset:48704
    ds_read_b64_tr_b16 v[120:121], v10 offset:46176
    ds_read_b64_tr_b16 v[122:123], v10 offset:48736
    ds_read_b64_tr_b16 v[124:125], v10 offset:46208
    ds_read_b64_tr_b16 v[126:127], v10 offset:48768
L_hst2:
    s_waitcnt vmcnt(3)
    v_max3_u32 v2, v48, v49, v50
    v_max_u32 v2, v2, v51
    v_cmp_eq_u32 vcc, -1, v2
    s_nop 1
    s_cmp_eq_u64 vcc, 0
    s_cbranch_scc0 L_hbad2
L_hok2:
    s_mov_b32 s56, 786432
    buffer_load_dwordx4 v[64:67], v12, s[40:43], s56 offen sc1
    s_waitcnt lgkmcnt(15)
    v_mfma_f32_16x16x32_bf16 v[20:23], v[128:131], v[48:51], v[20:23]
    v_mfma_f32_16x16x32_bf16 v[24:27], v[132:135], v[48:51], v[24:27]
    v_mfma_f32_16x16x32_bf16 v[28:31], v[136:139], v[48:51], v[28:31]
    v_mfma_f32_16x16x32_bf16 v[32:35], v[140:143], v[48:51], v[32:35]
    v_mfma_f32_16x16x32_bf16 v[36:39], v[144:147], v[48:51], v[36:39]
    ds_read_b64_tr_b16 v[128:129], v10 offset:51200
    ds_read_b64_tr_b16 v[130:131], v10 offset:53760
    ds_read_b64_tr_b16 v[132:133], v10 offset:51232
    ds_read_b64_tr_b16 v[134:135], v10 offset:53792
    ds_read_b64_tr_b16 v[136:137], v10 offset:51264
    ds_read_b64_tr_b16 v[138:139], v10 offset:53824
    ds_read_b64_tr_b16 v[140:141], v10 offset:51296
    ds_read_b64_tr_b16 v[142:143], v10 offset:53856
    ds_read_b64_tr_b16 v[144:145], v10 offset:51328
    ds_read_b64_tr_b16 v[146:147], v10 offset:53888
L_hst3:
    s_waitcnt vmcnt(3)
    v_max3_u32 v2, v52, v53, v54
    v_max_u32 v2, v2, v55
    v_cmp_eq_u32 vcc, -1, v2
    s_nop 1
    s_cmp_eq_u64 vcc, 0
    s_cbranch_scc0 L_hbad3
L_hok3:
    s_mov_b32 s56, 917504
    buffer_load_dwordx4 v[68:71], v12, s[40:43], s56 offen sc1
    s_waitcnt lgkmcnt(15)
    v_mfma_f32_16x16x32_bf16 v[20:23], v[148:151], v[52:55], v[20:23]
    v_mfma_f32_16x16x32_bf16 v[24:27], v[152:155], v[52:55], v[24:27]
    v_mfma_f32_16x16x32_bf16 v[28:31], v[156:159], v[52:55], v[28:31]
    v_mfma_f32_16x16x32_bf16 v[32:35], v[160:163], v[52:55], v[32:35]
    v_mfma_f32_16x16x32_bf16 v[36:39], v[164:167], v[52:55], v[36:39]
    ds_read_b64_tr_b16 v[148:149], v10 offset:56320
    ds_read_b64_tr_b16 v[150:151], v10 offset:58880
    ds_read_b64_tr_b16 v[152:153], v10 offset:56352
    ds_read_b64_tr_b16 v[154:155], v10 offset:58912
    ds_read_b64_tr_b16 v[156:157], v10 offset:56384
    ds_read_b64_tr_b16 v[158:159], v10 offset:58944
    ds_read_b64_tr_b16 v[160:161], v10 offset:56416
    ds_read_b64_tr_b16 v[162:163], v10 offset:58976
    ds_read_b64_tr_b16 v[164:165], v10 offset:56448
    ds_read_b64_tr_b16 v[166:167], v10 offset:59008
L_hst4:
    s_waitcnt vmcnt(3)
    v_max3_u32 v2, v56, v57, v58
    v_max_u32 v2, v2, v59
    v_cmp_eq_u32 vcc, -1, v2
    s_nop 1
    s_cmp_eq_u64 vcc, 0
    s_cbranch_scc0 L_hbad4
L_hok4:
    s_mov_b32 s56, 1048576
    buffer_load_dwordx4 v[72:75], v12, s[40:43], s56 offen sc1
    s_waitcnt lgkmcnt(15)
    v_mfma_f32_16x16x32_bf16 v[20:23], v[168:171], v[56:59], v[20:23]
    v_mfma_f32_16x16x32_bf16 v[24:27], v[172:175], v[56:59], v[24:27]
    v_mfma_f32_16x16x32_bf16 v[28:31], v[176:179], v[56:59], v[28:31]
    v_mfma_f32_16x16x32_bf16 v[32:35], v[180:183], v[56:59], v[32:35]
    v_mfma_f32_16x16x32_bf16 v[36:39], v[184:187], v[56:59], v[36:39]
L_hst5:
    s_waitcnt vmcnt(3)
    v_max3_u32 v2, v60, v61, v62
    v_max_u32 v2, v2, v63
    v_cmp_eq_u32 vcc, -1, v2
    s_nop 1
    s_cmp_eq_u64 vcc, 0
    s_cbranch_scc0 L_hbad5
L_hok5:
    s_mov_b32 s56, 1179648
    buffer_load_dwordx4 v[76:79], v12, s[40:43], s56 offen sc1
    s_waitcnt lgkmcnt(15)
    v_mfma_f32_16x16x32_bf16 v[20:23], v[188:191], v[60:63], v[20:23]
    v_mfma_f32_16x16x32_bf16 v[24:27], v[192:195], v[60:63], v[24:27]
    v_mfma_f32_16x16x32_bf16 v[28:31], v[196:199], v[60:63], v[28:31]
    v_mfma_f32_16x16x32_bf16 v[32:35], v[200:203], v[60:63], v[32:35]
    v_mfma_f32_16x16x32_bf16 v[36:39], v[204:207], v[60:63], v[36:39]
L_hst6:
    s_waitcnt vmcnt(3)
    v_max3_u32 v2, v64, v65, v66
    v_max_u32 v2, v2, v67
    v_cmp_eq_u32 vcc, -1, v2
    s_nop 1
    s_cmp_eq_u64 vcc, 0
    s_cbranch_scc0 L_hbad6
L_hok6:
    s_mov_b32 s56, 1310720
    buffer_load_dwordx4 v[80:83], v12, s[40:43], s56 offen sc1
    s_waitcnt lgkmcnt(15)
    v_mfma_f32_16x16x32_bf16 v[20:23], v[208:211], v[64:67], v[20:23]
    v_mfma_f32_16x16x32_bf16 v[24:27], v[212:215], v[64:67], v[24:27]
    v_mfma_f32_16x16x32_bf16 v[28:31], v[216:219], v[64:67], v[28:31]
    v_mfma_f32_16x16x32_bf16 v[32:35], v[220:223], v[64:67], v[32:35]
    v_mfma_f32_16x16x32_bf16 v[36:39], v[224:227], v[64:67], v[36:39]
L_hst7:
    s_waitcnt vmcnt(3)
    v_max3_u32 v2, v68, v69, v70
    v_max_u32 v2, v2, v71
    v_cmp_eq_u32 vcc, -1, v2
    s_nop 1
    s_cmp_eq_u64 vcc, 0
    s_cbranch_scc0 L_hbad7
L_hok7:
    s_mov_b32 s56, 1441792
    buffer_load_dwordx4 v[84:87], v12, s[40:43], s56 offen sc1
    s_waitcnt lgkmcnt(15)
    v_mfma_f32_16x16x32_bf16 v[20:23], v[228:231], v[68:71], v[20:23]
    v_mfma_f32_16x16x32_bf16 v[24:27], v[232:235], v[68:71], v[24:27]
    v_mfma_f32_16x16x32_bf16 v[28:31], v[236:239], v[68:71], v[28:31]
    v_mfma_f32_16x16x32_bf16 v[32:35], v[240:243], v[68:71], v[32:35]
    v_mfma_f32_16x16x32_bf16 v[36:39], v[244:247], v[68:71], v[36:39]
L_hst8:
    s_waitcnt vmcnt(3)
    v_max3_u32 v2, v72, v73, v74
    v_max_u32 v2, v2, v75
    v_cmp_eq_u32 vcc, -1, v2
    s_nop 1
    s_cmp_eq_u64 vcc, 0
    s_cbranch_scc0 L_hbad8
L_hok8:
    s_waitcnt lgkmcnt(15)
    v_mfma_f32_16x16x32_bf16 v[20:23], v[88:91], v[72:75], v[20:23]
    v_mfma_f32_16x16x32_bf16 v[24:27], v[92:95], v[72:75], v[24:27]
    v_mfma_f32_16x16x32_bf16 v[28:31], v[96:99], v[72:75], v[28:31]
    v_mfma_f32_16x16x32_bf16 v[32:35], v[100:103], v[72:75], v[32:35]
    v_mfma_f32_16x16x32_bf16 v[36:39], v[104:107], v[72:75], v[36:39]
L_hst9:
    s_waitcnt vmcnt(2)
    v_max3_u32 v2, v76, v77, v78
    v_max_u32 v2, v2, v79
    v_cmp_eq_u32 vcc, -1, v2
    s_nop 1
    s_cmp_eq_u64 vcc, 0
    s_cbranch_scc0 L_hbad9
L_hok9:
    s_waitcnt lgkmcnt(15)
    v_mfma_f32_16x16x32_bf16 v[20:23], v[108:111], v[76:79], v[20:23]
    v_mfma_f32_16x16x32_bf16 v[24:27], v[112:115], v[76:79], v[24:27]
    v_mfma_f32_16x16x32_bf16 v[28:31], v[116:119], v[76:79], v[28:31]
    v_mfma_f32_16x16x32_bf16 v[32:35], v[120:123], v[76:79], v[32:35]
    v_mfma_f32_16x16x32_bf16 v[36:39], v[124:127], v[76:79], v[36:39]
L_hst10:
    s_waitcnt vmcnt(1)
    v_max3_u32 v2, v80, v81, v82
    v_max_u32 v2, v2, v83
    v_cmp_eq_u32 vcc, -1, v2
    s_nop 1
    s_cmp_eq_u64 vcc, 0
    s_cbranch_scc0 L_hbad10
L_hok10:
    s_waitcnt lgkmcnt(10)
    v_mfma_f32_16x16x32_bf16 v[20:23], v[128:131], v[80:83], v[20:23]
    v_mfma_f32_16x16x32_bf16 v[24:27], v[132:135], v[80:83], v[24:27]
    v_mfma_f32_16x16x32_bf16 v[28:31], v[136:139], v[80:83], v[28:31]
    v_mfma_f32_16x16x32_bf16 v[32:35], v[140:143], v[80:83], v[32:35]
    v_mfma_f32_16x16x32_bf16 v[36:39], v[144:147], v[80:83], v[36:39]
L_hst11:
    s_waitcnt vmcnt(0)
    v_max3_u32 v2, v84, v85, v86
    v_max_u32 v2, v2, v87
    v_cmp_eq_u32 vcc, -1, v2
    s_nop 1
    s_cmp_eq_u64 vcc, 0
    s_cbranch_scc0 L_hbad11
L_hok11:
    s_waitcnt lgkmcnt(0)
    v_mfma_f32_16x16x32_bf16 v[20:23], v[148:151], v[84:87], v[20:23]
    v_mfma_f32_16x16x32_bf16 v[24:27], v[152:155], v[84:87], v[24:27]
    v_mfma_f32_16x16x32_bf16 v[28:31], v[156:159], v[84:87], v[28:31]
    v_mfma_f32_16x16x32_bf16 v[32:35], v[160:163], v[84:87], v[32:35]
    v_mfma_f32_16x16x32_bf16 v[36:39], v[164:167], v[84:87], v[36:39]
    s_nop 7
    ds_write_b128 v15, v[20:23] offset:0
    ds_write_b128 v15, v[24:27] offset:1024
    ds_write_b128 v15, v[28:31] offset:2048
    s_waitcnt lgkmcnt(0)
    s_barrier
    ds_read_b128 v[240:243], v14 offset:0
    ds_read_b128 v[244:247], v14 offset:1024
    s_waitcnt lgkmcnt(1)
    v_add_f32 v32, v32, v240
    v_add_f32 v33, v33, v241
    v_add_f32 v34, v34, v242
    v_add_f32 v35, v35, v243
    v_cvt_pk_bf16_f32 v32, v32, v33
    v_cvt_pk_bf16_f32 v33, v34, v35
    buffer_store_dwordx2 v[32:33], v13, s[36:39], 0 offen offset:96
    s_waitcnt lgkmcnt(0)
    v_add_f32 v36, v36, v244
    v_add_f32 v37, v37, v245
    v_add_f32 v38, v38, v246
    v_add_f32 v39, v39, v247
    v_cvt_pk_bf16_f32 v36, v36, v37
    v_cvt_pk_bf16_f32 v37, v38, v39
    buffer_store_dwordx2 v[36:37], v13, s[36:39], 0 offen offset:128
L_dend:
L_end:
    s_endpgm
L_p2sub:
    s_mov_b32 s59, 1600000
L_hw:
    ds_read_b32 v2, v8 offset:56
    s_waitcnt lgkmcnt(0)
    v_readfirstlane_b32 s56, v2
    s_nop 1
    s_cmp_eq_u32 s56, 4
    s_cbranch_scc0 L_hws
L_hwd:
    s_cmp_lg_u32 s52, 4
    s_cbranch_scc1 L_hp2
    s_and_b32 s56, s54, 3
    s_lshl_b32 s98, s53, 2
    s_add_u32 s98, s98, s56
    s_lshr_b32 s99, s54, 2
    s_mul_i32 s56, s98, 20
    v_bfe_u32 v2, v1, 4, 1
    v_mul_u32_u24 v2, 19, v2
    v_add_u32 v2, s56, v2
    v_lshrrev_b32 v2, 7, v2
    v_lshrrev_b32 v3, 5, v1
    v_mul_u32_u24 v3, 5, v3
    v_add3_u32 v3, v3, v2, 5
    v_and_b32 v4, 15, v1
    v_lshl_add_u32 v3, v3, 4, v4
    v_lshlrev_b32 v7, 7, v3
    v_lshlrev_b32 v6, 2, v1
    s_mov_b32 s59, 200000
L_p2:
    s_mov_b32 s57, 4096
    buffer_load_dword v4, v7, s[44:47], s57 offen sc1
    s_mov_b32 s57, 53248
    buffer_load_dword v5, v6, s[44:47], s57 offen sc1
    s_waitcnt vmcnt(0)
    v_xor_b32 v4, s55, v4
    v_xor_b32 v5, s55, v5
    v_or_b32 v4, v4, v5
    v_cmp_ne_u32 vcc, 0, v4
    s_nop 1
    s_cmp_eq_u64 vcc, 0
    s_cbranch_scc1 L_p2d
    s_sleep 6
    s_sub_u32 s59, s59, 1
    s_cmp_lg_u32 s59, 0
    s_cbranch_scc1 L_p2
L_p2d:
    v_mov_b32 v2, 1
    ds_write_b32 v8, v2 offset:24
L_hp2:
    s_setpc_b64 s[62:63]
L_slow:
    s_waitcnt vmcnt(0) lgkmcnt(0)
    s_add_u32 s56, s50, 2949120
    s_add_u32 s28, s26, s56
    s_addc_u32 s29, s27, 0
    s_and_b32 s29, s29, 0xffff
    s_mov_b32 s30, 0x288000
    s_mov_b32 s31, 0x20000
    s_add_u32 s32, s26, 0x558000
    s_addc_u32 s33, s27, 0
    s_and_b32 s33, s33, 0xffff
    s_mov_b32 s34, 0x288000
    s_mov_b32 s35, 0x20000
    s_mov_b64 exec, s[94:95]
    v_mov_b64 v[40:41], 0
    s_mov_b64 exec, -1
    v_mov_b32 v13, 0xff800000
    s_mov_b32 s58, 0
L_s1:
    s_bfe_u32 s56, s58, 0x10009
    s_mul_i32 s56, s56, 504
    s_sub_u32 s56, s58, s56
    buffer_load_dwordx2 v[64:65], v11, s[28:31], s56 offen
    buffer_load_dwordx4 v[48:51], v10, s[28:31], s58 offen
    s_waitcnt vmcnt(0)
    v_mfma_f32_32x32x16_bf16 v[152:167], v[48:51], v[24:27], 0
    s_nop 11
    v_mfma_f32_32x32x8_bf16 v[152:167], v[64:65], v[40:41], v[152:167]
    s_nop 12
    v_max3_f32 v13, v13, v152, v153
    v_max3_f32 v13, v13, v154, v155
    v_max3_f32 v13, v13, v156, v157
    v_max3_f32 v13, v13, v158, v159
    v_max3_f32 v13, v13, v160, v161
    v_max3_f32 v13, v13, v162, v163
    v_max3_f32 v13, v13, v164, v165
    v_max3_f32 v13, v13, v166, v167
    s_add_u32 s58, s58, 512
    s_cmp_lt_u32 s58, 32768
    s_cbranch_scc1 L_s1
    v_mov_b32 v2, v13
    s_nop 1
    v_permlane32_swap_b32 v2, v13
    s_nop 1
    v_max_f32 v13, v13, v2
    v_cvt_pk_bf16_f32 v152, 0, -v13
    v_sub_f32 v2, 0, v13
    v_sub_f32 v2, v2, v152
    v_cvt_pk_bf16_f32 v153, 0, v2
    v_sub_f32 v3, v2, v153
    s_mov_b64 exec, s[94:95]
    v_cvt_pk_bf16_f32 v40, v152, v153
    v_cvt_pk_bf16_f32 v41, v3, 0
    s_mov_b64 exec, -1
    v_mov_b64 v[168:169], 0
    v_mov_b64 v[170:171], 0
    v_mov_b64 v[172:173], 0
    v_mov_b64 v[174:175], 0
    v_mov_b64 v[176:177], 0
    v_mov_b64 v[178:179], 0
    v_mov_b64 v[180:181], 0
    v_mov_b64 v[182:183], 0
    s_mov_b32 s58, 0
    s_mov_b32 s59, 0
L_s2:
    buffer_load_dwordx4 v[72:75], v14, s[32:35], s59 offen
    buffer_load_dwordx4 v[76:79], v15, s[32:35], s59 offen
    s_bfe_u32 s56, s58, 0x10009
    s_mul_i32 s56, s56, 504
    s_sub_u32 s56, s58, s56
    buffer_load_dwordx2 v[64:65], v11, s[28:31], s56 offen
    buffer_load_dwordx4 v[48:51], v10, s[28:31], s58 offen
    s_waitcnt vmcnt(0)
    v_mfma_f32_32x32x16_bf16 v[152:167], v[48:51], v[24:27], 0
    s_nop 11
    v_mfma_f32_32x32x8_bf16 v[152:167], v[64:65], v[40:41], v[152:167]
    s_nop 12
    v_exp_f32 v152, v152
    v_exp_f32 v153, v153
    v_exp_f32 v154, v154
    v_exp_f32 v155, v155
    v_exp_f32 v156, v156
    v_exp_f32 v157, v157
    v_exp_f32 v158, v158
    v_exp_f32 v159, v159
    v_exp_f32 v160, v160
    v_exp_f32 v161, v161
    v_exp_f32 v162, v162
    v_exp_f32 v163, v163
    v_exp_f32 v164, v164
    v_exp_f32 v165, v165
    v_exp_f32 v166, v166
    v_exp_f32 v167, v167
    s_nop 1
    v_smfmac_f32_32x32x32_bf16 v[168:183], v[72:75], v[152:159], v12
    v_smfmac_f32_32x32x32_bf16 v[168:183], v[76:79], v[160:167], v12
    s_add_u32 s58, s58, 512
    s_add_u32 s59, s59, 41472
    s_cmp_lt_u32 s58, 32768
    s_cbranch_scc1 L_s2
    s_nop 12
    v_mov_b32 v180, v176
    v_mov_b32 v181, v176
    s_nop 1
    v_permlane32_swap_b32 v181, v180
    s_nop 1
    s_setpc_b64 s[48:49]
L_f1s:
    s_sleep 1
    s_sub_u32 s59, s59, 1
    s_cmp_lg_u32 s59, 0
    s_cbranch_scc1 L_f1
    s_branch L_f1d
L_g0s:
    s_sleep 1
    s_sub_u32 s59, s59, 1
    s_cmp_lg_u32 s59, 0
    s_cbranch_scc1 L_g0
    s_branch L_g0d
L_was:
    s_sleep 2
    s_sub_u32 s59, s59, 1
    s_cmp_lg_u32 s59, 0
    s_cbranch_scc1 L_wa
    s_branch L_wad
L_pas:
    s_sleep 4
    s_sub_u32 s59, s59, 1
    s_cmp_lg_u32 s59, 0
    s_cbranch_scc1 L_pa
    s_branch L_pad
L_wxs:
    ds_read_b32 v2, v246 offset:32
    ds_read_b32 v3, v8 offset:48
    s_sleep 0
    s_sub_u32 s59, s59, 1
    s_cmp_lg_u32 s59, 0
    s_cbranch_scc1 L_wx
    s_waitcnt lgkmcnt(0)
    s_branch L_wxd
L_sl0:
    v_mov_b64 v[24:25], v[32:33]
    v_mov_b64 v[26:27], v[34:35]
    v_mov_b64 v[40:41], v[44:45]
    s_call_b64 s[48:49], L_slow
    v_mov_b64 v[200:201], v[168:169]
    v_mov_b64 v[202:203], v[170:171]
    v_mov_b64 v[204:205], v[172:173]
    v_mov_b64 v[206:207], v[174:175]
    v_mov_b64 v[208:209], v[176:177]
    v_mov_b64 v[210:211], v[178:179]
    v_mov_b64 v[212:213], v[180:181]
    s_branch L_fin0
L_sl1:
    v_mov_b64 v[24:25], v[36:37]
    v_mov_b64 v[26:27], v[38:39]
    v_mov_b64 v[40:41], v[46:47]
    s_call_b64 s[48:49], L_slow
    v_mov_b64 v[216:217], v[168:169]
    v_mov_b64 v[218:219], v[170:171]
    v_mov_b64 v[220:221], v[172:173]
    v_mov_b64 v[222:223], v[174:175]
    v_mov_b64 v[224:225], v[176:177]
    v_mov_b64 v[226:227], v[178:179]
    v_mov_b64 v[228:229], v[180:181]
    s_branch L_fin1
L_cbad0:
    s_sleep 4
    s_mov_b32 s56, 0
    buffer_load_dwordx4 v[200:203], v238, s[40:43], s56 offen sc1
    s_waitcnt vmcnt(1)
    v_max3_u32 v2, v204, v205, v206
    v_max_u32 v2, v2, v207
    v_cmp_eq_u32 vcc, -1, v2
    s_nop 1
    s_cmp_eq_u64 vcc, 0
    s_cbranch_scc1 L_cw0_1
    s_mov_b32 s56, 131072
    buffer_load_dwordx4 v[204:207], v238, s[40:43], s56 offen sc1
L_cw0_1:
    v_max3_u32 v2, v208, v209, v210
    v_max_u32 v2, v2, v211
    v_cmp_eq_u32 vcc, -1, v2
    s_nop 1
    s_cmp_eq_u64 vcc, 0
    s_cbranch_scc1 L_cw0_2
    s_mov_b32 s56, 262144
    buffer_load_dwordx4 v[208:211], v238, s[40:43], s56 offen sc1
L_cw0_2:
    v_max3_u32 v2, v212, v213, v214
    v_max_u32 v2, v2, v215
    v_cmp_eq_u32 vcc, -1, v2
    s_nop 1
    s_cmp_eq_u64 vcc, 0
    s_cbranch_scc1 L_cw0_3
    s_mov_b32 s56, 393216
    buffer_load_dwordx4 v[212:215], v238, s[40:43], s56 offen sc1
L_cw0_3:
    s_waitcnt vmcnt(0)
    s_sub_u32 s59, s59, 1
    s_cmp_gt_i32 s59, 0
    s_cbranch_scc1 L_cst0
    s_branch L_cok0
L_cbad1:
    s_sleep 4
    s_mov_b32 s56, 131072
    buffer_load_dwordx4 v[204:207], v238, s[40:43], s56 offen sc1
    s_waitcnt vmcnt(1)
    v_max3_u32 v2, v208, v209, v210
    v_max_u32 v2, v2, v211
    v_cmp_eq_u32 vcc, -1, v2
    s_nop 1
    s_cmp_eq_u64 vcc, 0
    s_cbranch_scc1 L_cw1_2
    s_mov_b32 s56, 262144
    buffer_load_dwordx4 v[208:211], v238, s[40:43], s56 offen sc1
L_cw1_2:
    v_max3_u32 v2, v212, v213, v214
    v_max_u32 v2, v2, v215
    v_cmp_eq_u32 vcc, -1, v2
    s_nop 1
    s_cmp_eq_u64 vcc, 0
    s_cbranch_scc1 L_cw1_3
    s_mov_b32 s56, 393216
    buffer_load_dwordx4 v[212:215], v238, s[40:43], s56 offen sc1
L_cw1_3:
    v_max3_u32 v2, v216, v217, v218
    v_max_u32 v2, v2, v219
    v_cmp_eq_u32 vcc, -1, v2
    s_nop 1
    s_cmp_eq_u64 vcc, 0
    s_cbranch_scc1 L_cw1_4
    s_mov_b32 s56, 524288
    buffer_load_dwordx4 v[216:219], v238, s[40:43], s56 offen sc1
L_cw1_4:
    s_waitcnt vmcnt(0)
    s_sub_u32 s59, s59, 1
    s_cmp_gt_i32 s59, 0
    s_cbranch_scc1 L_cst1
    s_branch L_cok1
L_cbad2:
    s_sleep 4
    s_mov_b32 s56, 262144
    buffer_load_dwordx4 v[208:211], v238, s[40:43], s56 offen sc1
    s_waitcnt vmcnt(1)
    v_max3_u32 v2, v212, v213, v214
    v_max_u32 v2, v2, v215
    v_cmp_eq_u32 vcc, -1, v2
    s_nop 1
    s_cmp_eq_u64 vcc, 0
    s_cbranch_scc1 L_cw2_3
    s_mov_b32 s56, 393216
    buffer_load_dwordx4 v[212:215], v238, s[40:43], s56 offen sc1
L_cw2_3:
    v_max3_u32 v2, v216, v217, v218
    v_max_u32 v2, v2, v219
    v_cmp_eq_u32 vcc, -1, v2
    s_nop 1
    s_cmp_eq_u64 vcc, 0
    s_cbranch_scc1 L_cw2_4
    s_mov_b32 s56, 524288
    buffer_load_dwordx4 v[216:219], v238, s[40:43], s56 offen sc1
L_cw2_4:
    v_max3_u32 v2, v220, v221, v222
    v_max_u32 v2, v2, v223
    v_cmp_eq_u32 vcc, -1, v2
    s_nop 1
    s_cmp_eq_u64 vcc, 0
    s_cbranch_scc1 L_cw2_5
    s_mov_b32 s56, 655360
    buffer_load_dwordx4 v[220:223], v238, s[40:43], s56 offen sc1
L_cw2_5:
    s_waitcnt vmcnt(0)
    s_sub_u32 s59, s59, 1
    s_cmp_gt_i32 s59, 0
    s_cbranch_scc1 L_cst2
    s_branch L_cok2
L_cbad3:
    s_sleep 4
    s_mov_b32 s56, 393216
    buffer_load_dwordx4 v[212:215], v238, s[40:43], s56 offen sc1
    s_waitcnt vmcnt(1)
    v_max3_u32 v2, v216, v217, v218
    v_max_u32 v2, v2, v219
    v_cmp_eq_u32 vcc, -1, v2
    s_nop 1
    s_cmp_eq_u64 vcc, 0
    s_cbranch_scc1 L_cw3_4
    s_mov_b32 s56, 524288
    buffer_load_dwordx4 v[216:219], v238, s[40:43], s56 offen sc1
L_cw3_4:
    v_max3_u32 v2, v220, v221, v222
    v_max_u32 v2, v2, v223
    v_cmp_eq_u32 vcc, -1, v2
    s_nop 1
    s_cmp_eq_u64 vcc, 0
    s_cbranch_scc1 L_cw3_5
    s_mov_b32 s56, 655360
    buffer_load_dwordx4 v[220:223], v238, s[40:43], s56 offen sc1
L_cw3_5:
    v_max3_u32 v2, v224, v225, v226
    v_max_u32 v2, v2, v227
    v_cmp_eq_u32 vcc, -1, v2
    s_nop 1
    s_cmp_eq_u64 vcc, 0
    s_cbranch_scc1 L_cw3_6
    s_mov_b32 s56, 786432
    buffer_load_dwordx4 v[224:227], v238, s[40:43], s56 offen sc1
L_cw3_6:
    s_waitcnt vmcnt(0)
    s_sub_u32 s59, s59, 1
    s_cmp_gt_i32 s59, 0
    s_cbranch_scc1 L_cst3
    s_branch L_cok3
L_cbad4:
    s_sleep 4
    s_mov_b32 s56, 524288
    buffer_load_dwordx4 v[216:219], v238, s[40:43], s56 offen sc1
    s_waitcnt vmcnt(1)
    v_max3_u32 v2, v220, v221, v222
    v_max_u32 v2, v2, v223
    v_cmp_eq_u32 vcc, -1, v2
    s_nop 1
    s_cmp_eq_u64 vcc, 0
    s_cbranch_scc1 L_cw4_5
    s_mov_b32 s56, 655360
    buffer_load_dwordx4 v[220:223], v238, s[40:43], s56 offen sc1
L_cw4_5:
    v_max3_u32 v2, v224, v225, v226
    v_max_u32 v2, v2, v227
    v_cmp_eq_u32 vcc, -1, v2
    s_nop 1
    s_cmp_eq_u64 vcc, 0
    s_cbranch_scc1 L_cw4_6
    s_mov_b32 s56, 786432
    buffer_load_dwordx4 v[224:227], v238, s[40:43], s56 offen sc1
L_cw4_6:
    v_max3_u32 v2, v228, v229, v230
    v_max_u32 v2, v2, v231
    v_cmp_eq_u32 vcc, -1, v2
    s_nop 1
    s_cmp_eq_u64 vcc, 0
    s_cbranch_scc1 L_cw4_7
    s_mov_b32 s56, 917504
    buffer_load_dwordx4 v[228:231], v238, s[40:43], s56 offen sc1
L_cw4_7:
    s_waitcnt vmcnt(0)
    s_sub_u32 s59, s59, 1
    s_cmp_gt_i32 s59, 0
    s_cbranch_scc1 L_cst4
    s_branch L_cok4
L_cbad5:
    s_sleep 4
    s_mov_b32 s56, 655360
    buffer_load_dwordx4 v[220:223], v238, s[40:43], s56 offen sc1
    s_waitcnt vmcnt(1)
    v_max3_u32 v2, v224, v225, v226
    v_max_u32 v2, v2, v227
    v_cmp_eq_u32 vcc, -1, v2
    s_nop 1
    s_cmp_eq_u64 vcc, 0
    s_cbranch_scc1 L_cw5_6
    s_mov_b32 s56, 786432
    buffer_load_dwordx4 v[224:227], v238, s[40:43], s56 offen sc1
L_cw5_6:
    v_max3_u32 v2, v228, v229, v230
    v_max_u32 v2, v2, v231
    v_cmp_eq_u32 vcc, -1, v2
    s_nop 1
    s_cmp_eq_u64 vcc, 0
    s_cbranch_scc1 L_cw5_7
    s_mov_b32 s56, 917504
    buffer_load_dwordx4 v[228:231], v238, s[40:43], s56 offen sc1
L_cw5_7:
    s_waitcnt vmcnt(0)
    s_sub_u32 s59, s59, 1
    s_cmp_gt_i32 s59, 0
    s_cbranch_scc1 L_cst5
    s_branch L_cok5
L_cbad6:
    s_sleep 4
    s_mov_b32 s56, 786432
    buffer_load_dwordx4 v[224:227], v238, s[40:43], s56 offen sc1
    s_waitcnt vmcnt(1)
    v_max3_u32 v2, v228, v229, v230
    v_max_u32 v2, v2, v231
    v_cmp_eq_u32 vcc, -1, v2
    s_nop 1
    s_cmp_eq_u64 vcc, 0
    s_cbranch_scc1 L_cw6_7
    s_mov_b32 s56, 917504
    buffer_load_dwordx4 v[228:231], v238, s[40:43], s56 offen sc1
L_cw6_7:
    s_waitcnt vmcnt(0)
    s_sub_u32 s59, s59, 1
    s_cmp_gt_i32 s59, 0
    s_cbranch_scc1 L_cst6
    s_branch L_cok6
L_cbad7:
    s_sleep 4
    s_mov_b32 s56, 917504
    buffer_load_dwordx4 v[228:231], v238, s[40:43], s56 offen sc1
    s_waitcnt vmcnt(1)
    s_waitcnt vmcnt(0)
    s_sub_u32 s59, s59, 1
    s_cmp_gt_i32 s59, 0
    s_cbranch_scc1 L_cst7
    s_branch L_cok7
L_wbs:
    s_sleep 1
    s_sub_u32 s59, s59, 1
    s_cmp_lg_u32 s59, 0
    s_cbranch_scc1 L_wb
    s_branch L_wbd
L_wgs:
    s_sleep 1
    s_sub_u32 s59, s59, 1
    s_cmp_lg_u32 s59, 0
    s_cbranch_scc1 L_wg
    s_branch L_wgd
L_hbs:
    s_sleep 4
    s_sub_u32 s59, s59, 1
    s_cmp_lg_u32 s59, 0
    s_cbranch_scc1 L_hb
    s_branch L_hbd
L_hrs:
    s_sleep 4
    s_sub_u32 s59, s59, 1
    s_cmp_lg_u32 s59, 0
    s_cbranch_scc1 L_hr
    s_branch L_hrd
L_hqs:
    s_sleep 4
    s_sub_u32 s59, s59, 1
    s_cmp_lg_u32 s59, 0
    s_cbranch_scc1 L_hq
    s_branch L_hqd
L_his:
    s_sleep 4
    s_sub_u32 s59, s59, 1
    s_cmp_lg_u32 s59, 0
    s_cbranch_scc1 L_hi
    s_branch L_hid
L_hbad0:
    s_sleep 4
    s_mov_b32 s56, 0
    buffer_load_dwordx4 v[40:43], v12, s[40:43], s56 offen sc1
    s_waitcnt vmcnt(1)
    v_max3_u32 v2, v44, v45, v46
    v_max_u32 v2, v2, v47
    v_cmp_eq_u32 vcc, -1, v2
    s_nop 1
    s_cmp_eq_u64 vcc, 0
    s_cbranch_scc1 L_hw0_1
    s_mov_b32 s56, 131072
    buffer_load_dwordx4 v[44:47], v12, s[40:43], s56 offen sc1
L_hw0_1:
    v_max3_u32 v2, v48, v49, v50
    v_max_u32 v2, v2, v51
    v_cmp_eq_u32 vcc, -1, v2
    s_nop 1
    s_cmp_eq_u64 vcc, 0
    s_cbranch_scc1 L_hw0_2
    s_mov_b32 s56, 262144
    buffer_load_dwordx4 v[48:51], v12, s[40:43], s56 offen sc1
L_hw0_2:
    v_max3_u32 v2, v52, v53, v54
    v_max_u32 v2, v2, v55
    v_cmp_eq_u32 vcc, -1, v2
    s_nop 1
    s_cmp_eq_u64 vcc, 0
    s_cbranch_scc1 L_hw0_3
    s_mov_b32 s56, 393216
    buffer_load_dwordx4 v[52:55], v12, s[40:43], s56 offen sc1
L_hw0_3:
    s_waitcnt vmcnt(0)
    s_sub_u32 s59, s59, 1
    s_cmp_gt_i32 s59, 0
    s_cbranch_scc1 L_hst0
    s_branch L_hok0
L_hbad1:
    s_sleep 4
    s_mov_b32 s56, 131072
    buffer_load_dwordx4 v[44:47], v12, s[40:43], s56 offen sc1
    s_waitcnt vmcnt(1)
    v_max3_u32 v2, v48, v49, v50
    v_max_u32 v2, v2, v51
    v_cmp_eq_u32 vcc, -1, v2
    s_nop 1
    s_cmp_eq_u64 vcc, 0
    s_cbranch_scc1 L_hw1_2
    s_mov_b32 s56, 262144
    buffer_load_dwordx4 v[48:51], v12, s[40:43], s56 offen sc1
L_hw1_2:
    v_max3_u32 v2, v52, v53, v54
    v_max_u32 v2, v2, v55
    v_cmp_eq_u32 vcc, -1, v2
    s_nop 1
    s_cmp_eq_u64 vcc, 0
    s_cbranch_scc1 L_hw1_3
    s_mov_b32 s56, 393216
    buffer_load_dwordx4 v[52:55], v12, s[40:43], s56 offen sc1
L_hw1_3:
    v_max3_u32 v2, v56, v57, v58
    v_max_u32 v2, v2, v59
    v_cmp_eq_u32 vcc, -1, v2
    s_nop 1
    s_cmp_eq_u64 vcc, 0
    s_cbranch_scc1 L_hw1_4
    s_mov_b32 s56, 524288
    buffer_load_dwordx4 v[56:59], v12, s[40:43], s56 offen sc1
L_hw1_4:
    s_waitcnt vmcnt(0)
    s_sub_u32 s59, s59, 1
    s_cmp_gt_i32 s59, 0
    s_cbranch_scc1 L_hst1
    s_branch L_hok1
L_hbad2:
    s_sleep 4
    s_mov_b32 s56, 262144
    buffer_load_dwordx4 v[48:51], v12, s[40:43], s56 offen sc1
    s_waitcnt vmcnt(1)
    v_max3_u32 v2, v52, v53, v54
    v_max_u32 v2, v2, v55
    v_cmp_eq_u32 vcc, -1, v2
    s_nop 1
    s_cmp_eq_u64 vcc, 0
    s_cbranch_scc1 L_hw2_3
    s_mov_b32 s56, 393216
    buffer_load_dwordx4 v[52:55], v12, s[40:43], s56 offen sc1
L_hw2_3:
    v_max3_u32 v2, v56, v57, v58
    v_max_u32 v2, v2, v59
    v_cmp_eq_u32 vcc, -1, v2
    s_nop 1
    s_cmp_eq_u64 vcc, 0
    s_cbranch_scc1 L_hw2_4
    s_mov_b32 s56, 524288
    buffer_load_dwordx4 v[56:59], v12, s[40:43], s56 offen sc1
L_hw2_4:
    v_max3_u32 v2, v60, v61, v62
    v_max_u32 v2, v2, v63
    v_cmp_eq_u32 vcc, -1, v2
    s_nop 1
    s_cmp_eq_u64 vcc, 0
    s_cbranch_scc1 L_hw2_5
    s_mov_b32 s56, 655360
    buffer_load_dwordx4 v[60:63], v12, s[40:43], s56 offen sc1
L_hw2_5:
    s_waitcnt vmcnt(0)
    s_sub_u32 s59, s59, 1
    s_cmp_gt_i32 s59, 0
    s_cbranch_scc1 L_hst2
    s_branch L_hok2
L_hbad3:
    s_sleep 4
    s_mov_b32 s56, 393216
    buffer_load_dwordx4 v[52:55], v12, s[40:43], s56 offen sc1
    s_waitcnt vmcnt(1)
    v_max3_u32 v2, v56, v57, v58
    v_max_u32 v2, v2, v59
    v_cmp_eq_u32 vcc, -1, v2
    s_nop 1
    s_cmp_eq_u64 vcc, 0
    s_cbranch_scc1 L_hw3_4
    s_mov_b32 s56, 524288
    buffer_load_dwordx4 v[56:59], v12, s[40:43], s56 offen sc1
L_hw3_4:
    v_max3_u32 v2, v60, v61, v62
    v_max_u32 v2, v2, v63
    v_cmp_eq_u32 vcc, -1, v2
    s_nop 1
    s_cmp_eq_u64 vcc, 0
    s_cbranch_scc1 L_hw3_5
    s_mov_b32 s56, 655360
    buffer_load_dwordx4 v[60:63], v12, s[40:43], s56 offen sc1
L_hw3_5:
    v_max3_u32 v2, v64, v65, v66
    v_max_u32 v2, v2, v67
    v_cmp_eq_u32 vcc, -1, v2
    s_nop 1
    s_cmp_eq_u64 vcc, 0
    s_cbranch_scc1 L_hw3_6
    s_mov_b32 s56, 786432
    buffer_load_dwordx4 v[64:67], v12, s[40:43], s56 offen sc1
L_hw3_6:
    s_waitcnt vmcnt(0)
    s_sub_u32 s59, s59, 1
    s_cmp_gt_i32 s59, 0
    s_cbranch_scc1 L_hst3
    s_branch L_hok3
L_hbad4:
    s_sleep 4
    s_mov_b32 s56, 524288
    buffer_load_dwordx4 v[56:59], v12, s[40:43], s56 offen sc1
    s_waitcnt vmcnt(1)
    v_max3_u32 v2, v60, v61, v62
    v_max_u32 v2, v2, v63
    v_cmp_eq_u32 vcc, -1, v2
    s_nop 1
    s_cmp_eq_u64 vcc, 0
    s_cbranch_scc1 L_hw4_5
    s_mov_b32 s56, 655360
    buffer_load_dwordx4 v[60:63], v12, s[40:43], s56 offen sc1
L_hw4_5:
    v_max3_u32 v2, v64, v65, v66
    v_max_u32 v2, v2, v67
    v_cmp_eq_u32 vcc, -1, v2
    s_nop 1
    s_cmp_eq_u64 vcc, 0
    s_cbranch_scc1 L_hw4_6
    s_mov_b32 s56, 786432
    buffer_load_dwordx4 v[64:67], v12, s[40:43], s56 offen sc1
L_hw4_6:
    v_max3_u32 v2, v68, v69, v70
    v_max_u32 v2, v2, v71
    v_cmp_eq_u32 vcc, -1, v2
    s_nop 1
    s_cmp_eq_u64 vcc, 0
    s_cbranch_scc1 L_hw4_7
    s_mov_b32 s56, 917504
    buffer_load_dwordx4 v[68:71], v12, s[40:43], s56 offen sc1
L_hw4_7:
    s_waitcnt vmcnt(0)
    s_sub_u32 s59, s59, 1
    s_cmp_gt_i32 s59, 0
    s_cbranch_scc1 L_hst4
    s_branch L_hok4
L_hbad5:
    s_sleep 4
    s_mov_b32 s56, 655360
    buffer_load_dwordx4 v[60:63], v12, s[40:43], s56 offen sc1
    s_waitcnt vmcnt(1)
    v_max3_u32 v2, v64, v65, v66
    v_max_u32 v2, v2, v67
    v_cmp_eq_u32 vcc, -1, v2
    s_nop 1
    s_cmp_eq_u64 vcc, 0
    s_cbranch_scc1 L_hw5_6
    s_mov_b32 s56, 786432
    buffer_load_dwordx4 v[64:67], v12, s[40:43], s56 offen sc1
L_hw5_6:
    v_max3_u32 v2, v68, v69, v70
    v_max_u32 v2, v2, v71
    v_cmp_eq_u32 vcc, -1, v2
    s_nop 1
    s_cmp_eq_u64 vcc, 0
    s_cbranch_scc1 L_hw5_7
    s_mov_b32 s56, 917504
    buffer_load_dwordx4 v[68:71], v12, s[40:43], s56 offen sc1
L_hw5_7:
    v_max3_u32 v2, v72, v73, v74
    v_max_u32 v2, v2, v75
    v_cmp_eq_u32 vcc, -1, v2
    s_nop 1
    s_cmp_eq_u64 vcc, 0
    s_cbranch_scc1 L_hw5_8
    s_mov_b32 s56, 1048576
    buffer_load_dwordx4 v[72:75], v12, s[40:43], s56 offen sc1
L_hw5_8:
    s_waitcnt vmcnt(0)
    s_sub_u32 s59, s59, 1
    s_cmp_gt_i32 s59, 0
    s_cbranch_scc1 L_hst5
    s_branch L_hok5
L_hbad6:
    s_sleep 4
    s_mov_b32 s56, 786432
    buffer_load_dwordx4 v[64:67], v12, s[40:43], s56 offen sc1
    s_waitcnt vmcnt(1)
    v_max3_u32 v2, v68, v69, v70
    v_max_u32 v2, v2, v71
    v_cmp_eq_u32 vcc, -1, v2
    s_nop 1
    s_cmp_eq_u64 vcc, 0
    s_cbranch_scc1 L_hw6_7
    s_mov_b32 s56, 917504
    buffer_load_dwordx4 v[68:71], v12, s[40:43], s56 offen sc1
L_hw6_7:
    v_max3_u32 v2, v72, v73, v74
    v_max_u32 v2, v2, v75
    v_cmp_eq_u32 vcc, -1, v2
    s_nop 1
    s_cmp_eq_u64 vcc, 0
    s_cbranch_scc1 L_hw6_8
    s_mov_b32 s56, 1048576
    buffer_load_dwordx4 v[72:75], v12, s[40:43], s56 offen sc1
L_hw6_8:
    v_max3_u32 v2, v76, v77, v78
    v_max_u32 v2, v2, v79
    v_cmp_eq_u32 vcc, -1, v2
    s_nop 1
    s_cmp_eq_u64 vcc, 0
    s_cbranch_scc1 L_hw6_9
    s_mov_b32 s56, 1179648
    buffer_load_dwordx4 v[76:79], v12, s[40:43], s56 offen sc1
L_hw6_9:
    s_waitcnt vmcnt(0)
    s_sub_u32 s59, s59, 1
    s_cmp_gt_i32 s59, 0
    s_cbranch_scc1 L_hst6
    s_branch L_hok6
L_hbad7:
    s_sleep 4
    s_mov_b32 s56, 917504
    buffer_load_dwordx4 v[68:71], v12, s[40:43], s56 offen sc1
    s_waitcnt vmcnt(1)
    v_max3_u32 v2, v72, v73, v74
    v_max_u32 v2, v2, v75
    v_cmp_eq_u32 vcc, -1, v2
    s_nop 1
    s_cmp_eq_u64 vcc, 0
    s_cbranch_scc1 L_hw7_8
    s_mov_b32 s56, 1048576
    buffer_load_dwordx4 v[72:75], v12, s[40:43], s56 offen sc1
L_hw7_8:
    v_max3_u32 v2, v76, v77, v78
    v_max_u32 v2, v2, v79
    v_cmp_eq_u32 vcc, -1, v2
    s_nop 1
    s_cmp_eq_u64 vcc, 0
    s_cbranch_scc1 L_hw7_9
    s_mov_b32 s56, 1179648
    buffer_load_dwordx4 v[76:79], v12, s[40:43], s56 offen sc1
L_hw7_9:
    v_max3_u32 v2, v80, v81, v82
    v_max_u32 v2, v2, v83
    v_cmp_eq_u32 vcc, -1, v2
    s_nop 1
    s_cmp_eq_u64 vcc, 0
    s_cbranch_scc1 L_hw7_10
    s_mov_b32 s56, 1310720
    buffer_load_dwordx4 v[80:83], v12, s[40:43], s56 offen sc1
L_hw7_10:
    s_waitcnt vmcnt(0)
    s_sub_u32 s59, s59, 1
    s_cmp_gt_i32 s59, 0
    s_cbranch_scc1 L_hst7
    s_branch L_hok7
L_hbad8:
    s_sleep 4
    s_mov_b32 s56, 1048576
    buffer_load_dwordx4 v[72:75], v12, s[40:43], s56 offen sc1
    s_waitcnt vmcnt(1)
    v_max3_u32 v2, v76, v77, v78
    v_max_u32 v2, v2, v79
    v_cmp_eq_u32 vcc, -1, v2
    s_nop 1
    s_cmp_eq_u64 vcc, 0
    s_cbranch_scc1 L_hw8_9
    s_mov_b32 s56, 1179648
    buffer_load_dwordx4 v[76:79], v12, s[40:43], s56 offen sc1
L_hw8_9:
    v_max3_u32 v2, v80, v81, v82
    v_max_u32 v2, v2, v83
    v_cmp_eq_u32 vcc, -1, v2
    s_nop 1
    s_cmp_eq_u64 vcc, 0
    s_cbranch_scc1 L_hw8_10
    s_mov_b32 s56, 1310720
    buffer_load_dwordx4 v[80:83], v12, s[40:43], s56 offen sc1
L_hw8_10:
    v_max3_u32 v2, v84, v85, v86
    v_max_u32 v2, v2, v87
    v_cmp_eq_u32 vcc, -1, v2
    s_nop 1
    s_cmp_eq_u64 vcc, 0
    s_cbranch_scc1 L_hw8_11
    s_mov_b32 s56, 1441792
    buffer_load_dwordx4 v[84:87], v12, s[40:43], s56 offen sc1
L_hw8_11:
    s_waitcnt vmcnt(0)
    s_sub_u32 s59, s59, 1
    s_cmp_gt_i32 s59, 0
    s_cbranch_scc1 L_hst8
    s_branch L_hok8
L_hbad9:
    s_sleep 4
    s_mov_b32 s56, 1179648
    buffer_load_dwordx4 v[76:79], v12, s[40:43], s56 offen sc1
    s_waitcnt vmcnt(1)
    v_max3_u32 v2, v80, v81, v82
    v_max_u32 v2, v2, v83
    v_cmp_eq_u32 vcc, -1, v2
    s_nop 1
    s_cmp_eq_u64 vcc, 0
    s_cbranch_scc1 L_hw9_10
    s_mov_b32 s56, 1310720
    buffer_load_dwordx4 v[80:83], v12, s[40:43], s56 offen sc1
L_hw9_10:
    v_max3_u32 v2, v84, v85, v86
    v_max_u32 v2, v2, v87
    v_cmp_eq_u32 vcc, -1, v2
    s_nop 1
    s_cmp_eq_u64 vcc, 0
    s_cbranch_scc1 L_hw9_11
    s_mov_b32 s56, 1441792
    buffer_load_dwordx4 v[84:87], v12, s[40:43], s56 offen sc1
L_hw9_11:
    s_waitcnt vmcnt(0)
    s_sub_u32 s59, s59, 1
    s_cmp_gt_i32 s59, 0
    s_cbranch_scc1 L_hst9
    s_branch L_hok9
L_hbad10:
    s_sleep 4
    s_mov_b32 s56, 1310720
    buffer_load_dwordx4 v[80:83], v12, s[40:43], s56 offen sc1
    s_waitcnt vmcnt(1)
    v_max3_u32 v2, v84, v85, v86
    v_max_u32 v2, v2, v87
    v_cmp_eq_u32 vcc, -1, v2
    s_nop 1
    s_cmp_eq_u64 vcc, 0
    s_cbranch_scc1 L_hw10_11
    s_mov_b32 s56, 1441792
    buffer_load_dwordx4 v[84:87], v12, s[40:43], s56 offen sc1
L_hw10_11:
    s_waitcnt vmcnt(0)
    s_sub_u32 s59, s59, 1
    s_cmp_gt_i32 s59, 0
    s_cbranch_scc1 L_hst10
    s_branch L_hok10
L_hbad11:
    s_sleep 4
    s_mov_b32 s56, 1441792
    buffer_load_dwordx4 v[84:87], v12, s[40:43], s56 offen sc1
    s_waitcnt vmcnt(1)
    s_waitcnt vmcnt(0)
    s_sub_u32 s59, s59, 1
    s_cmp_gt_i32 s59, 0
    s_cbranch_scc1 L_hst11
    s_branch L_hok11
L_hws:
    s_sleep 4
    s_sub_u32 s59, s59, 1
    s_cmp_lg_u32 s59, 0
    s_cbranch_scc1 L_hw
    s_branch L_hwd
L_cend:
.section .rodata,"a"
.p2align 6
.amdhsa_kernel gated_mix__spectral_fnet__softmax_full_mha__prompt_kernel
  .amdhsa_next_free_vgpr 256
  .amdhsa_next_free_sgpr 102
  .amdhsa_accum_offset 256
  .amdhsa_group_segment_fixed_size 0
  .amdhsa_kernarg_size 96
  .amdhsa_user_sgpr_count 2
  .amdhsa_user_sgpr_kernarg_segment_ptr 1
  .amdhsa_system_sgpr_workgroup_id_x 1
.end_amdhsa_kernel
```
